```python
import torch

def _softmax(x, axis=-1):
    return torch.softmax(x, dim=axis)

def _gelu(x):
    return torch.nn.functional.gelu(x, approximate='tanh')

def _silu(x):
    return torch.nn.functional.silu(x)

def _sigmoid(x):
    return torch.sigmoid(x)

def _layernorm(x, axis=-1, eps=1e-05):
    m = x.mean(dim=axis, keepdim=True)
    v = x.var(dim=axis, keepdim=True, unbiased=False)
    return (x - m) / torch.sqrt(v + eps)

def _scatter_add(tgt, idx, src, axis=0):
    return tgt.clone().index_add_(axis, idx, src)

def _segment_sum(src, seg, n):
    out = torch.zeros((n,) + src.shape[1:], dtype=src.dtype)
    return out.index_add_(0, seg, src)

def _pad(x, pw):
    flat = tuple((v for pair in reversed(pw) for v in pair))
    return torch.nn.functional.pad(x, flat)
kernel_name = 'adaLN_cond__spectral_fnet__swiglu_ffn__prompt'

def setup_inputs():

    _w = lambda a: (lambda t: t.to(torch.bfloat16) if t.is_floating_point() else t)(torch.as_tensor(a))

    def _A_setup():
        B, S, D = (1, 2048, 512)
        ns = torch.arange(S)[:, None] * torch.arange(S)[None, :]
        nd = torch.arange(D)[:, None] * torch.arange(D)[None, :]
        Ws_re = torch.cos(-2.0 * torch.pi * ns / S).to(float)
        Ws_im = torch.sin(-2.0 * torch.pi * ns / S).to(float)
        Wd_re = torch.cos(-2.0 * torch.pi * nd / D).to(float)
        Wd_im = torch.sin(-2.0 * torch.pi * nd / D).to(float)
        return {'x': _w((lambda *s: torch.randn(*s, dtype=torch.bfloat16) * 0.05)(B, S, D)), 'dft_seq_re': _w(Ws_re), 'dft_seq_im': _w(Ws_im), 'dft_hid_re': _w(Wd_re), 'dft_hid_im': _w(Wd_im)}
    _A_in = _A_setup()

    def _B_setup():
        B, S, D, F = (1, 2048, 512, 1376)
        return {'x': _w((lambda *s: torch.randn(*s, dtype=torch.bfloat16) * 0.05)(B, S, D)), 'w_gate': _w((lambda *s: torch.randn(*s, dtype=torch.bfloat16) * 0.4)(D, F)), 'w_up': _w((lambda *s: torch.randn(*s, dtype=torch.bfloat16) * 0.4)(D, F)), 'w_down': _w((lambda *s: torch.randn(*s, dtype=torch.bfloat16) * 0.4)(F, D))}
    _B_in = _B_setup()
    return {'A_x': _A_in['x'], 'A_dft_seq_re': _A_in['dft_seq_re'], 'A_dft_seq_im': _A_in['dft_seq_im'], 'A_dft_hid_re': _A_in['dft_hid_re'], 'A_dft_hid_im': _A_in['dft_hid_im'], 'B_x': _B_in['x'], 'B_w_gate': _B_in['w_gate'], 'B_w_up': _B_in['w_up'], 'B_w_down': _B_in['w_down'], 'c': _w((lambda *s: torch.randn(*s, dtype=torch.bfloat16) * 0.2)(1, 512) * 8.0), 'w_mod': _w((lambda *s: torch.randn(*s, dtype=torch.bfloat16) * 0.2)(512, 6 * 512) * 512 ** (-0.5) * 8.0)}

def reference(A_x, A_dft_seq_re, A_dft_seq_im, A_dft_hid_re, A_dft_hid_im, B_x, B_w_gate, B_w_up, B_w_down, c, w_mod):

    def _A_ref(x, dft_seq_re, dft_seq_im, dft_hid_re, dft_hid_im):
        a = torch.einsum('bsd,ed->bse', x, dft_hid_re)
        b = torch.einsum('bsd,ed->bse', x, dft_hid_im)
        y = torch.einsum('ts,bse->bte', dft_seq_re, a) - torch.einsum('ts,bse->bte', dft_seq_im, b)
        return y

    def _B_ref(x, w_gate, w_up, w_down):
        g = _silu(x @ w_gate)
        u = x @ w_up
        return g * u @ w_down
    x = A_x
    mod = (_silu(c) @ w_mod).reshape(c.shape[0], 6, 1, -1)
    sa, ca, ga, sb, cb, gb = (mod[:, 0].clone(), mod[:, 1].clone(), mod[:, 2].clone(), mod[:, 3].clone(), mod[:, 4].clone(), mod[:, 5].clone())
    h = _layernorm(x, axis=-1) * (1 + ca) + sa
    x = x + ga * _A_ref(h, A_dft_seq_re, A_dft_seq_im, A_dft_hid_re, A_dft_hid_im)
    h = _layernorm(x, axis=-1) * (1 + cb) + sb
    x = x + gb * _B_ref(h, B_w_gate, B_w_up, B_w_down)
    return x
```

```asm
; @launch grid=(256,1,1) block=(256,1,1) lds=163840
.amdgcn_target "amdgcn-amd-amdhsa--gfx950"
.text
.globl adaLN_cond__spectral_fnet__swiglu_ffn__prompt_kernel
.p2align 8
.type adaLN_cond__spectral_fnet__swiglu_ffn__prompt_kernel,@function
adaLN_cond__spectral_fnet__swiglu_ffn__prompt_kernel:
  s_cmp_ge_u32 s2, 256
  s_cbranch_scc1 .done_1
  s_load_dwordx2 s[4:5], s[0:1], 0
  s_load_dwordx2 s[24:25], s[0:1], 80
  s_load_dwordx2 s[20:21], s[0:1], 72
  s_load_dwordx2 s[32:33], s[0:1], 104
  s_load_dwordx2 s[8:9], s[0:1], 48
  s_load_dwordx2 s[12:13], s[0:1], 56
  s_load_dwordx2 s[16:17], s[0:1], 64
  s_load_dwordx2 s[28:29], s[0:1], 88
  v_lshrrev_b32 v2, 6, v0
  v_and_b32 v1, 63, v0
  v_readfirstlane_b32 s3, v2
  v_and_b32 v2, 15, v0
  v_bfe_u32 v3, v0, 4, 2
  s_cmp_ge_u32 s2, 128
  s_cbranch_scc1 .k1mod_2
  s_and_b32 s38, s2, 7
  s_lshr_b32 s39, s2, 3
  s_lshr_b32 s40, s39, 2
  s_lshl_b32 s40, s40, 3
  s_add_u32 s36, s38, s40
  s_and_b32 s37, s39, 3
  v_lshrrev_b32 v4, 2, v1
  v_sub_u32 v5, 0, v3
  v_xor_b32 v5, v5, v1
  v_and_b32 v5, 3, v5
  v_lshlrev_b32 v4, 15, v4
  v_lshl_add_u32 v4, v5, 4, v4
  s_lshl_b32 s38, s3, 9
  s_add_u32 s38, s38, s36
  s_lshl_b32 s38, s38, 10
  s_mul_i32 s39, s3, 16640
  s_add_u32 s39, s39, 97280
  s_mov_b32 s6, 2097152
  s_mov_b32 s7, 0x20000
  s_waitcnt lgkmcnt(0)
  s_add_u32 m0, s39, 0
  s_nop 0
  buffer_load_dwordx4 v4, s[4:7], s38 offen offset:0  lds
  s_add_u32 m0, s39, 976
  s_nop 0
  buffer_load_dwordx4 v4, s[4:7], s38 offen offset:64  lds
  s_add_u32 m0, s39, 1952
  s_nop 0
  buffer_load_dwordx4 v4, s[4:7], s38 offen offset:128  lds
  s_add_u32 m0, s39, 2928
  s_nop 0
  buffer_load_dwordx4 v4, s[4:7], s38 offen offset:192  lds
  s_add_u32 m0, s39, 3904
  s_nop 0
  buffer_load_dwordx4 v4, s[4:7], s38 offen offset:256  lds
  s_add_u32 m0, s39, 4880
  s_nop 0
  buffer_load_dwordx4 v4, s[4:7], s38 offen offset:320  lds
  s_add_u32 m0, s39, 5856
  s_nop 0
  buffer_load_dwordx4 v4, s[4:7], s38 offen offset:384  lds
  s_add_u32 m0, s39, 6832
  s_nop 0
  buffer_load_dwordx4 v4, s[4:7], s38 offen offset:448  lds
  s_add_u32 m0, s39, 7808
  s_nop 0
  buffer_load_dwordx4 v4, s[4:7], s38 offen offset:512  lds
  s_add_u32 m0, s39, 8784
  s_nop 0
  buffer_load_dwordx4 v4, s[4:7], s38 offen offset:576  lds
  s_add_u32 m0, s39, 9760
  s_nop 0
  buffer_load_dwordx4 v4, s[4:7], s38 offen offset:640  lds
  s_add_u32 m0, s39, 10736
  s_nop 0
  buffer_load_dwordx4 v4, s[4:7], s38 offen offset:704  lds
  s_add_u32 m0, s39, 11712
  s_nop 0
  buffer_load_dwordx4 v4, s[4:7], s38 offen offset:768  lds
  s_add_u32 m0, s39, 12688
  s_nop 0
  buffer_load_dwordx4 v4, s[4:7], s38 offen offset:832  lds
  s_add_u32 m0, s39, 13664
  s_nop 0
  buffer_load_dwordx4 v4, s[4:7], s38 offen offset:896  lds
  s_add_u32 m0, s39, 14640
  s_nop 0
  buffer_load_dwordx4 v4, s[4:7], s38 offen offset:960  lds
  s_getpc_b64 s[72:73]
  s_and_b32 s72, s72, 0xffffff00
  s_lshr_b32 s74, s2, 3
  s_lshl_b32 s74, s74, 2
  s_add_u32 s74, s74, s3
  s_and_b32 s74, s74, 15
  s_lshl_b32 s74, s74, 11
  v_and_b32 v250, 15, v0
  v_lshlrev_b32 v250, 7, v250
  v_add_u32 v250, s74, v250
  v_min_u32 v250, .Lend-adaLN_cond__spectral_fnet__swiglu_ffn__prompt_kernel, v250
  global_load_dword v249, v250, s[72:73]
  s_mov_b32 s10, 1409024
  s_mov_b32 s11, 0x20000
  s_mov_b32 s14, 1409024
  s_mov_b32 s15, 0x20000
  s_mov_b32 s18, 1409024
  s_mov_b32 s19, 0x20000
  s_mov_b32 s30, 2097152
  s_mov_b32 s31, 0x20000
  s_mov_b32 s34, 16777216
  s_mov_b32 s35, 0x20000
  s_add_u32 s72, s32, 14680064
  s_addc_u32 s73, s33, 0
  s_load_dword s64, s[72:73], 0
  s_and_b32 s72, s2, 1
  s_lshl_b32 s72, s72, 3
  s_lshr_b32 s73, s2, 5
  s_add_u32 s72, s72, s73
  s_mul_i32 s66, s72, 192
  s_cmp_eq_u32 s72, 15
  s_cselect_b32 s66, 0x200000, s66
  s_mul_i32 s67, s3, 3072
  s_mul_i32 s72, s3, 192
  s_mov_b32 s73, 0x15555556
  v_add_u32 v240, s72, v1
  v_add_u32 v240, 0, v240
  v_mul_hi_u32 v244, v240, s73
  v_mul_u32_u24 v245, 12, v244
  v_sub_u32 v240, v240, v245
  v_lshlrev_b32 v240, 4, v240
  v_mul_u32_u24 v244, 2752, v244
  v_add_u32 v240, v240, v244
  v_add_u32 v241, s72, v1
  v_add_u32 v241, 64, v241
  v_mul_hi_u32 v244, v241, s73
  v_mul_u32_u24 v245, 12, v244
  v_sub_u32 v241, v241, v245
  v_lshlrev_b32 v241, 4, v241
  v_mul_u32_u24 v244, 2752, v244
  v_add_u32 v241, v241, v244
  v_add_u32 v242, s72, v1
  v_add_u32 v242, 128, v242
  v_mul_hi_u32 v244, v242, s73
  v_mul_u32_u24 v245, 12, v244
  v_sub_u32 v242, v242, v245
  v_lshlrev_b32 v242, 4, v242
  v_mul_u32_u24 v244, 2752, v244
  v_add_u32 v242, v242, v244
  v_lshlrev_b32 v5, 3, v3
  v_cvt_f32_u32 v5, v5
  s_and_b32 s40, s3, 1
  s_lshl_b32 s40, s40, 4
  v_add_u32 v6, s40, v2
  v_cmp_eq_u32 vcc, 0, v6
  v_cvt_f32_u32 v6, v6
  v_mul_f32 v6, 0x3c800000, v6
  v_mov_b32 v8, 0x3e800000
  v_cndmask_b32 v9, v6, 0.5, vcc
  v_cndmask_b32 v10, v8, 0, vcc
  v_add_f32 v48, 0x00000000, v5
  v_mul_f32 v16, v48, v6
  v_fma_f32 v32, v48, v9, v10
  v_add_f32 v48, 0x3f800000, v5
  v_mul_f32 v17, v48, v6
  v_fma_f32 v33, v48, v9, v10
  v_add_f32 v48, 0x40000000, v5
  v_mul_f32 v18, v48, v6
  v_fma_f32 v34, v48, v9, v10
  v_add_f32 v48, 0x40400000, v5
  v_mul_f32 v19, v48, v6
  v_fma_f32 v35, v48, v9, v10
  v_add_f32 v48, 0x40800000, v5
  v_mul_f32 v20, v48, v6
  v_fma_f32 v36, v48, v9, v10
  v_add_f32 v48, 0x40a00000, v5
  v_mul_f32 v21, v48, v6
  v_fma_f32 v37, v48, v9, v10
  v_add_f32 v48, 0x40c00000, v5
  v_mul_f32 v22, v48, v6
  v_fma_f32 v38, v48, v9, v10
  v_add_f32 v48, 0x40e00000, v5
  v_mul_f32 v23, v48, v6
  v_fma_f32 v39, v48, v9, v10
  v_add_f32 v48, 0x42000000, v5
  v_mul_f32 v24, v48, v6
  v_fma_f32 v40, v48, v9, v10
  v_add_f32 v48, 0x42040000, v5
  v_mul_f32 v25, v48, v6
  v_fma_f32 v41, v48, v9, v10
  v_add_f32 v48, 0x42080000, v5
  v_mul_f32 v26, v48, v6
  v_fma_f32 v42, v48, v9, v10
  v_add_f32 v48, 0x420c0000, v5
  v_mul_f32 v27, v48, v6
  v_fma_f32 v43, v48, v9, v10
  v_add_f32 v48, 0x42100000, v5
  v_mul_f32 v28, v48, v6
  v_fma_f32 v44, v48, v9, v10
  v_add_f32 v48, 0x42140000, v5
  v_mul_f32 v29, v48, v6
  v_fma_f32 v45, v48, v9, v10
  v_add_f32 v48, 0x42180000, v5
  v_mul_f32 v30, v48, v6
  v_fma_f32 v46, v48, v9, v10
  v_add_f32 v48, 0x421c0000, v5
  v_mul_f32 v31, v48, v6
  v_fma_f32 v47, v48, v9, v10
  v_cos_f32 v16, v16
  v_cos_f32 v17, v17
  v_cos_f32 v18, v18
  v_cos_f32 v19, v19
  v_cos_f32 v20, v20
  v_cos_f32 v21, v21
  v_cos_f32 v22, v22
  v_cos_f32 v23, v23
  v_cos_f32 v24, v24
  v_cos_f32 v25, v25
  v_cos_f32 v26, v26
  v_cos_f32 v27, v27
  v_cos_f32 v28, v28
  v_cos_f32 v29, v29
  v_cos_f32 v30, v30
  v_cos_f32 v31, v31
  v_cos_f32 v32, v32
  v_cos_f32 v33, v33
  v_cos_f32 v34, v34
  v_cos_f32 v35, v35
  v_cos_f32 v36, v36
  v_cos_f32 v37, v37
  v_cos_f32 v38, v38
  v_cos_f32 v39, v39
  v_cos_f32 v40, v40
  v_cos_f32 v41, v41
  v_cos_f32 v42, v42
  v_cos_f32 v43, v43
  v_cos_f32 v44, v44
  v_cos_f32 v45, v45
  v_cos_f32 v46, v46
  v_cos_f32 v47, v47
  v_mov_b32 v112, 0x3f803f80
  v_mov_b32 v113, 0x3f803f80
  v_mov_b32 v114, 0x3f803f80
  v_mov_b32 v115, 0x3f803f80
  v_lshrrev_b32 v5, 2, v2
  v_sub_u32 v5, 0, v5
  v_xor_b32 v5, v5, v3
  v_and_b32 v5, 3, v5
  v_lshlrev_b32 v5, 4, v5
  v_lshl_add_u32 v5, v2, 6, v5
  v_add_u32 v5, s39, v5
  v_lshrrev_b32 v6, 1, v3
  v_mul_u32_u24 v6, 16640, v6
  v_and_b32 v7, 3, v1
  v_mul_u32_u24 v7, 1040, v7
  v_add_u32 v6, v6, v7
  v_and_b32 v7, 1, v3
  v_lshl_add_u32 v6, v7, 9, v6
  v_bfe_u32 v8, v1, 2, 2
  v_lshl_add_u32 v6, v8, 6, v6
  s_lshr_b32 s41, s3, 1
  s_mul_i32 s42, s41, 8320
  s_add_u32 s42, s42, 97280
  v_add_u32 v6, s42, v6
  v_lshlrev_b32 v7, 1, v7
  v_xor_b32 v8, s37, v7
  v_lshl_add_u32 v11, v8, 4, v6
  v_xor_b32 v8, 3, v8
  v_lshl_add_u32 v12, v8, 4, v6
  v_add_u32 v12, 256, v12
  s_lshl_b32 s42, s3, 6
  s_add_u32 s42, s42, 96896
  v_lshl_add_u32 v7, v2, 2, s42
  s_lshl_b32 s42, s3, 5
  s_add_u32 s42, s42, 97152
  v_lshl_add_u32 v13, v2, 1, s42
  v_lshlrev_b32 v8, 5, v3
  v_add_u32 v8, 96896, v8
  v_lshlrev_b32 v14, 4, v3
  v_add_u32 v14, 97152, v14
  s_mov_b32 s42, 0x22222222
  s_mov_b32 s43, 0x22222222
  s_mov_b32 s44, 0x44444444
  s_mov_b32 s45, 0x44444444
  s_mov_b32 s46, 0x88888888
  s_mov_b32 s47, 0x88888888
  v_add_u32 v9, s40, v2
  v_mul_u32_u24 v9, 65536, v9
  v_lshl_add_u32 v9, v3, 4, v9
  s_mul_i32 s48, s36, 2048
  s_mul_i32 s49, s37, 512
  s_add_u32 s48, s48, s49
  s_lshl_b32 s49, s41, 7
  s_add_u32 s48, s48, s49
  s_add_u32 s48, s48, 0
  s_waitcnt vmcnt(16)
  ds_read_b128 v[48:51], v5 offset:0
  s_waitcnt vmcnt(15)
  ds_read_b128 v[52:55], v5 offset:1040
  s_waitcnt lgkmcnt(0)
  v_mfma_f32_16x16x32_bf16 v[116:119], v[48:51], v[48:51], 0
  v_mfma_f32_16x16x32_bf16 v[120:123], v[112:115], v[48:51], 0
  s_waitcnt vmcnt(14)
  ds_read_b128 v[56:59], v5 offset:2080
  v_mfma_f32_16x16x32_bf16 v[116:119], v[52:55], v[52:55], v[116:119]
  v_mfma_f32_16x16x32_bf16 v[120:123], v[112:115], v[52:55], v[120:123]
  s_waitcnt vmcnt(13)
  ds_read_b128 v[60:63], v5 offset:3120
  s_waitcnt lgkmcnt(1)
  v_mfma_f32_16x16x32_bf16 v[116:119], v[56:59], v[56:59], v[116:119]
  v_mfma_f32_16x16x32_bf16 v[120:123], v[112:115], v[56:59], v[120:123]
  s_waitcnt vmcnt(12)
  ds_read_b128 v[64:67], v5 offset:4160
  s_waitcnt lgkmcnt(1)
  v_mfma_f32_16x16x32_bf16 v[116:119], v[60:63], v[60:63], v[116:119]
  v_mfma_f32_16x16x32_bf16 v[120:123], v[112:115], v[60:63], v[120:123]
  s_waitcnt vmcnt(11)
  ds_read_b128 v[68:71], v5 offset:5200
  s_waitcnt lgkmcnt(1)
  v_mfma_f32_16x16x32_bf16 v[116:119], v[64:67], v[64:67], v[116:119]
  v_mfma_f32_16x16x32_bf16 v[120:123], v[112:115], v[64:67], v[120:123]
  s_waitcnt vmcnt(10)
  ds_read_b128 v[72:75], v5 offset:6240
  s_waitcnt lgkmcnt(1)
  v_mfma_f32_16x16x32_bf16 v[116:119], v[68:71], v[68:71], v[116:119]
  v_mfma_f32_16x16x32_bf16 v[120:123], v[112:115], v[68:71], v[120:123]
  s_waitcnt vmcnt(9)
  ds_read_b128 v[76:79], v5 offset:7280
  s_waitcnt lgkmcnt(1)
  v_mfma_f32_16x16x32_bf16 v[116:119], v[72:75], v[72:75], v[116:119]
  v_mfma_f32_16x16x32_bf16 v[120:123], v[112:115], v[72:75], v[120:123]
  s_waitcnt vmcnt(8)
  ds_read_b128 v[80:83], v5 offset:8320
  s_waitcnt lgkmcnt(1)
  v_mfma_f32_16x16x32_bf16 v[116:119], v[76:79], v[76:79], v[116:119]
  v_mfma_f32_16x16x32_bf16 v[120:123], v[112:115], v[76:79], v[120:123]
  s_waitcnt vmcnt(7)
  ds_read_b128 v[84:87], v5 offset:9360
  s_waitcnt lgkmcnt(1)
  v_mfma_f32_16x16x32_bf16 v[116:119], v[80:83], v[80:83], v[116:119]
  v_mfma_f32_16x16x32_bf16 v[120:123], v[112:115], v[80:83], v[120:123]
  s_waitcnt vmcnt(6)
  ds_read_b128 v[88:91], v5 offset:10400
  s_waitcnt lgkmcnt(1)
  v_mfma_f32_16x16x32_bf16 v[116:119], v[84:87], v[84:87], v[116:119]
  v_mfma_f32_16x16x32_bf16 v[120:123], v[112:115], v[84:87], v[120:123]
  s_waitcnt vmcnt(5)
  ds_read_b128 v[92:95], v5 offset:11440
  s_waitcnt lgkmcnt(1)
  v_mfma_f32_16x16x32_bf16 v[116:119], v[88:91], v[88:91], v[116:119]
  v_mfma_f32_16x16x32_bf16 v[120:123], v[112:115], v[88:91], v[120:123]
  s_waitcnt vmcnt(4)
  ds_read_b128 v[96:99], v5 offset:12480
  s_waitcnt lgkmcnt(1)
  v_mfma_f32_16x16x32_bf16 v[116:119], v[92:95], v[92:95], v[116:119]
  v_mfma_f32_16x16x32_bf16 v[120:123], v[112:115], v[92:95], v[120:123]
  s_waitcnt vmcnt(3)
  ds_read_b128 v[100:103], v5 offset:13520
  s_waitcnt lgkmcnt(1)
  v_mfma_f32_16x16x32_bf16 v[116:119], v[96:99], v[96:99], v[116:119]
  v_mfma_f32_16x16x32_bf16 v[120:123], v[112:115], v[96:99], v[120:123]
  s_waitcnt vmcnt(2)
  ds_read_b128 v[104:107], v5 offset:14560
  s_waitcnt lgkmcnt(1)
  v_mfma_f32_16x16x32_bf16 v[116:119], v[100:103], v[100:103], v[116:119]
  v_mfma_f32_16x16x32_bf16 v[120:123], v[112:115], v[100:103], v[120:123]
  s_waitcnt vmcnt(1)
  ds_read_b128 v[108:111], v5 offset:15600
  s_waitcnt lgkmcnt(1)
  v_mfma_f32_16x16x32_bf16 v[116:119], v[104:107], v[104:107], v[116:119]
  v_mfma_f32_16x16x32_bf16 v[120:123], v[112:115], v[104:107], v[120:123]
  s_barrier
  s_waitcnt lgkmcnt(0)
  v_mfma_f32_16x16x32_bf16 v[116:119], v[108:111], v[108:111], v[116:119]
  v_mfma_f32_16x16x32_bf16 v[120:123], v[112:115], v[108:111], v[120:123]
  ds_read_b64_tr_b16 v[128:129], v11 offset:0
  ds_read_b64_tr_b16 v[130:131], v12 offset:0
  ds_read_b64_tr_b16 v[132:133], v11 offset:33280
  ds_read_b64_tr_b16 v[134:135], v12 offset:33280
  ds_read_b64_tr_b16 v[136:137], v11 offset:8
  ds_read_b64_tr_b16 v[138:139], v12 offset:8
  ds_read_b64_tr_b16 v[140:141], v11 offset:33288
  ds_read_b64_tr_b16 v[142:143], v12 offset:33288
  ds_read_b64_tr_b16 v[144:145], v11 offset:4160
  ds_read_b64_tr_b16 v[146:147], v12 offset:4160
  ds_read_b64_tr_b16 v[148:149], v11 offset:37440
  ds_read_b64_tr_b16 v[150:151], v12 offset:37440
  ds_read_b64_tr_b16 v[152:153], v11 offset:4168
  ds_read_b64_tr_b16 v[154:155], v12 offset:4168
  ds_read_b64_tr_b16 v[156:157], v11 offset:37448
  ds_read_b64_tr_b16 v[158:159], v12 offset:37448
  v_cndmask_b32 v10, v116, v117, s[42:43]
  v_cndmask_b32 v10, v10, v118, s[44:45]
  v_cndmask_b32 v10, v10, v119, s[46:47]
  v_mul_f32 v15, 0xbb000000, v120
  v_mul_f32 v10, 0x3b000000, v10
  v_fma_f32 v10, -v15, v15, v10
  v_max_f32 v10, 0, v10
  v_cvt_pk_bf16_f32 v15, v15, v10
  v_and_b32 v10, 0xffff0000, v15
  v_add_f32 v10, 0x3727c5ac, v10
  v_cvt_pk_bf16_f32 v10, v10, v10
  v_lshlrev_b32 v10, 16, v10
  v_sqrt_f32 v10, v10
  s_nop 0
  v_cvt_pk_bf16_f32 v10, v10, v10
  v_lshlrev_b32 v10, 16, v10
  v_rcp_f32 v10, v10
  s_mov_b32 exec_lo, 0x00f0000f
  s_mov_b32 exec_hi, 0xf0000f00
  ds_write_b16 v13, v15
  ds_write_b32 v7, v10
  s_mov_b64 exec, -1
  s_waitcnt lgkmcnt(0)
  s_barrier
  ds_read_b128 v[48:51], v8 offset:0
  ds_read_b128 v[52:55], v8 offset:16
  ds_read_b128 v[64:67], v14 offset:0
  ds_read_b128 v[56:59], v8 offset:128
  ds_read_b128 v[60:63], v8 offset:144
  ds_read_b128 v[68:71], v14 offset:64
  s_waitcnt lgkmcnt(5)
  v_pk_mul_f32 v[16:17], v[16:17], v[48:49]
  v_pk_mul_f32 v[18:19], v[18:19], v[50:51]
  s_waitcnt lgkmcnt(4)
  v_pk_mul_f32 v[20:21], v[20:21], v[52:53]
  v_pk_mul_f32 v[22:23], v[22:23], v[54:55]
  v_cvt_pk_bf16_f32 v72, v16, v17
  v_cvt_pk_bf16_f32 v73, v18, v19
  v_cvt_pk_bf16_f32 v74, v20, v21
  v_cvt_pk_bf16_f32 v75, v22, v23
  v_pk_mul_f32 v[32:33], v[32:33], v[48:49]
  v_pk_mul_f32 v[34:35], v[34:35], v[50:51]
  v_pk_mul_f32 v[36:37], v[36:37], v[52:53]
  v_pk_mul_f32 v[38:39], v[38:39], v[54:55]
  v_cvt_pk_bf16_f32 v80, v32, v33
  v_cvt_pk_bf16_f32 v81, v34, v35
  v_cvt_pk_bf16_f32 v82, v36, v37
  v_cvt_pk_bf16_f32 v83, v38, v39
  s_waitcnt lgkmcnt(2)
  v_pk_mul_f32 v[24:25], v[24:25], v[56:57]
  v_pk_mul_f32 v[26:27], v[26:27], v[58:59]
  s_waitcnt lgkmcnt(1)
  v_pk_mul_f32 v[28:29], v[28:29], v[60:61]
  v_pk_mul_f32 v[30:31], v[30:31], v[62:63]
  v_cvt_pk_bf16_f32 v76, v24, v25
  v_cvt_pk_bf16_f32 v77, v26, v27
  v_cvt_pk_bf16_f32 v78, v28, v29
  v_cvt_pk_bf16_f32 v79, v30, v31
  v_pk_mul_f32 v[40:41], v[40:41], v[56:57]
  v_pk_mul_f32 v[42:43], v[42:43], v[58:59]
  v_pk_mul_f32 v[44:45], v[44:45], v[60:61]
  v_pk_mul_f32 v[46:47], v[46:47], v[62:63]
  v_cvt_pk_bf16_f32 v84, v40, v41
  v_cvt_pk_bf16_f32 v85, v42, v43
  v_cvt_pk_bf16_f32 v86, v44, v45
  v_cvt_pk_bf16_f32 v87, v46, v47
  v_mfma_f32_16x16x32_bf16 v[88:91], v[64:67], v[72:75], 0
  v_mfma_f32_16x16x32_bf16 v[92:95], v[64:67], v[80:83], 0
  s_waitcnt lgkmcnt(0)
  v_mfma_f32_16x16x32_bf16 v[88:91], v[68:71], v[76:79], v[88:91]
  v_mfma_f32_16x16x32_bf16 v[92:95], v[68:71], v[84:87], v[92:95]
  v_mfma_f32_16x16x32_bf16 v[160:163], v[128:131], v[72:75], v[88:91]
  v_mfma_f32_16x16x32_bf16 v[164:167], v[128:131], v[80:83], v[92:95]
  v_mfma_f32_16x16x32_bf16 v[160:163], v[132:135], v[76:79], v[160:163]
  v_mfma_f32_16x16x32_bf16 v[164:167], v[132:135], v[84:87], v[164:167]
  v_mfma_f32_16x16x32_bf16 v[168:171], v[136:139], v[72:75], v[88:91]
  v_mfma_f32_16x16x32_bf16 v[172:175], v[136:139], v[80:83], v[92:95]
  v_mfma_f32_16x16x32_bf16 v[168:171], v[140:143], v[76:79], v[168:171]
  v_mfma_f32_16x16x32_bf16 v[172:175], v[140:143], v[84:87], v[172:175]
  s_nop 3
  v_cvt_pk_bf16_f32 v96, v160, v164
  v_cvt_pk_bf16_f32 v97, v161, v165
  v_cvt_pk_bf16_f32 v98, v162, v166
  v_cvt_pk_bf16_f32 v99, v163, v167
  buffer_store_dwordx4 v[96:99], v9, s[32:35], s48 offen offset:0 sc1
  v_mfma_f32_16x16x32_bf16 v[176:179], v[144:147], v[72:75], v[88:91]
  v_mfma_f32_16x16x32_bf16 v[180:183], v[144:147], v[80:83], v[92:95]
  v_mfma_f32_16x16x32_bf16 v[176:179], v[148:151], v[76:79], v[176:179]
  v_mfma_f32_16x16x32_bf16 v[180:183], v[148:151], v[84:87], v[180:183]
  v_cvt_pk_bf16_f32 v100, v168, v172
  v_cvt_pk_bf16_f32 v101, v169, v173
  v_cvt_pk_bf16_f32 v102, v170, v174
  v_cvt_pk_bf16_f32 v103, v171, v175
  buffer_store_dwordx4 v[100:103], v9, s[32:35], s48 offen offset:256 sc1
  v_mfma_f32_16x16x32_bf16 v[184:187], v[152:155], v[72:75], v[88:91]
  v_mfma_f32_16x16x32_bf16 v[188:191], v[152:155], v[80:83], v[92:95]
  v_mfma_f32_16x16x32_bf16 v[184:187], v[156:159], v[76:79], v[184:187]
  v_mfma_f32_16x16x32_bf16 v[188:191], v[156:159], v[84:87], v[188:191]
  v_cvt_pk_bf16_f32 v104, v176, v180
  v_cvt_pk_bf16_f32 v105, v177, v181
  v_cvt_pk_bf16_f32 v106, v178, v182
  v_cvt_pk_bf16_f32 v107, v179, v183
  buffer_store_dwordx4 v[104:107], v9, s[32:35], s48 offen offset:64 sc1
  s_nop 2
  v_cvt_pk_bf16_f32 v108, v184, v188
  v_cvt_pk_bf16_f32 v109, v185, v189
  v_cvt_pk_bf16_f32 v110, v186, v190
  v_cvt_pk_bf16_f32 v111, v187, v191
  buffer_store_dwordx4 v[108:111], v9, s[32:35], s48 offen offset:320 sc1
  s_waitcnt lgkmcnt(0)
  s_mul_i32 s64, s64, 0x9e3779b1
  s_add_u32 s64, s64, 0x7f4a7c15
  s_lshl_b32 s62, s2, 6
  s_add_u32 s62, s62, 14684160
  s_waitcnt vmcnt(0) lgkmcnt(0)
  s_barrier
  s_cmp_lg_u32 s3, 0
  s_cbranch_scc1 .fs_5
  v_mov_b32 v250, 0
  v_mov_b32 v251, s64
  s_mov_b64 exec, 1
  buffer_store_dword v251, v250, s[32:35], s62 offen sc1
  s_mov_b64 exec, -1
.fs_5:
  s_branch .k1end_4
.k1mod_2:
  s_cmp_ge_u32 s2, 224
  s_cbranch_scc1 .k1idle_3
  s_and_b32 s38, s2, 7
  s_lshr_b32 s39, s2, 3
  s_mul_i32 s38, s38, 12
  s_add_u32 s36, s38, s39
  s_sub_u32 s36, s36, 16
  v_lshlrev_b32 v4, 2, v0
  s_mov_b32 s22, 1024
  s_mov_b32 s23, 0x20000
  s_mov_b32 s26, 3145728
  s_mov_b32 s27, 0x20000
  s_mov_b32 s6, 2097152
  s_mov_b32 s7, 0x20000
  v_lshrrev_b32 v5, 2, v1
  v_mul_u32_u24 v5, 6144, v5
  v_and_b32 v6, 3, v1
  v_lshl_add_u32 v5, v6, 4, v5
  s_mul_i32 s38, s3, 786432
  s_lshl_b32 s39, s36, 6
  s_add_u32 s38, s38, s39
  s_lshl_b32 s39, s3, 13
  s_add_u32 s39, s39, 97280
  s_waitcnt lgkmcnt(0)
  buffer_load_dword v8, v4, s[20:23], 0 offen
  s_add_u32 m0, s39, 0
  s_nop 0
  buffer_load_dwordx4 v5, s[24:27], s38 offen nt lds
  s_add_u32 m0, s39, 1024
  s_add_u32 s38, s38, 98304
  buffer_load_dwordx4 v5, s[24:27], s38 offen nt lds
  s_add_u32 m0, s39, 2048
  s_add_u32 s38, s38, 98304
  buffer_load_dwordx4 v5, s[24:27], s38 offen nt lds
  s_add_u32 m0, s39, 3072
  s_add_u32 s38, s38, 98304
  buffer_load_dwordx4 v5, s[24:27], s38 offen nt lds
  s_add_u32 m0, s39, 4096
  s_add_u32 s38, s38, 98304
  buffer_load_dwordx4 v5, s[24:27], s38 offen nt lds
  s_add_u32 m0, s39, 5120
  s_add_u32 s38, s38, 98304
  buffer_load_dwordx4 v5, s[24:27], s38 offen nt lds
  s_add_u32 m0, s39, 6144
  s_add_u32 s38, s38, 98304
  buffer_load_dwordx4 v5, s[24:27], s38 offen nt lds
  s_add_u32 m0, s39, 7168
  s_add_u32 s38, s38, 98304
  buffer_load_dwordx4 v5, s[24:27], s38 offen nt lds
  s_getpc_b64 s[72:73]
  s_and_b32 s72, s72, 0xffffff00
  s_lshr_b32 s74, s2, 3
  s_lshl_b32 s74, s74, 2
  s_add_u32 s74, s74, s3
  s_and_b32 s74, s74, 15
  s_lshl_b32 s74, s74, 11
  v_and_b32 v250, 15, v0
  v_lshlrev_b32 v250, 7, v250
  v_add_u32 v250, s74, v250
  v_min_u32 v250, .Lend-adaLN_cond__spectral_fnet__swiglu_ffn__prompt_kernel, v250
  global_load_dword v249, v250, s[72:73]
  s_mov_b32 s10, 1409024
  s_mov_b32 s11, 0x20000
  s_mov_b32 s14, 1409024
  s_mov_b32 s15, 0x20000
  s_mov_b32 s18, 1409024
  s_mov_b32 s19, 0x20000
  s_mov_b32 s30, 2097152
  s_mov_b32 s31, 0x20000
  s_mov_b32 s34, 16777216
  s_mov_b32 s35, 0x20000
  s_add_u32 s72, s32, 14680064
  s_addc_u32 s73, s33, 0
  s_load_dword s64, s[72:73], 0
  s_and_b32 s72, s2, 1
  s_lshl_b32 s72, s72, 3
  s_lshr_b32 s73, s2, 5
  s_add_u32 s72, s72, s73
  s_mul_i32 s66, s72, 192
  s_cmp_eq_u32 s72, 15
  s_cselect_b32 s66, 0x200000, s66
  s_mul_i32 s67, s3, 3072
  s_mul_i32 s72, s3, 192
  s_mov_b32 s73, 0x15555556
  v_add_u32 v240, s72, v1
  v_add_u32 v240, 0, v240
  v_mul_hi_u32 v244, v240, s73
  v_mul_u32_u24 v245, 12, v244
  v_sub_u32 v240, v240, v245
  v_lshlrev_b32 v240, 4, v240
  v_mul_u32_u24 v244, 2752, v244
  v_add_u32 v240, v240, v244
  v_add_u32 v241, s72, v1
  v_add_u32 v241, 64, v241
  v_mul_hi_u32 v244, v241, s73
  v_mul_u32_u24 v245, 12, v244
  v_sub_u32 v241, v241, v245
  v_lshlrev_b32 v241, 4, v241
  v_mul_u32_u24 v244, 2752, v244
  v_add_u32 v241, v241, v244
  v_add_u32 v242, s72, v1
  v_add_u32 v242, 128, v242
  v_mul_hi_u32 v244, v242, s73
  v_mul_u32_u24 v245, 12, v244
  v_sub_u32 v242, v242, v245
  v_lshlrev_b32 v242, 4, v242
  v_mul_u32_u24 v244, 2752, v244
  v_add_u32 v242, v242, v244
  s_lshl_b32 s70, s2, 2
  s_add_u32 s70, s70, s3
  s_and_b32 s70, s70, 511
  s_mul_i32 s70, s70, 22
  v_min_u32 v246, 21, v1
  v_add_u32 v246, s70, v246
  v_lshlrev_b32 v246, 7, v246
  v_bfe_u32 v6, v1, 2, 2
  v_lshl_add_u32 v6, v3, 3, v6
  v_lshlrev_b32 v6, 6, v6
  v_and_b32 v7, 3, v1
  v_lshl_add_u32 v6, v7, 3, v6
  v_add_u32 v6, s39, v6
  v_add_u32 v4, 130048, v4
  s_lshl_b32 s40, s3, 8
  s_add_u32 s40, s40, 130048
  v_lshl_add_u32 v7, v3, 4, s40
  s_waitcnt vmcnt(9)
  v_lshlrev_b32 v9, 16, v8
  v_and_b32 v10, 0xffff0000, v8
  v_mul_f32 v11, 0xbfb8aa3b, v9
  v_mul_f32 v12, 0xbfb8aa3b, v10
  v_exp_f32 v11, v11
  v_exp_f32 v12, v12
  v_add_f32 v11, 1.0, v11
  v_add_f32 v12, 1.0, v12
  v_rcp_f32 v11, v11
  v_rcp_f32 v12, v12
  v_mul_f32 v9, v9, v11
  v_mul_f32 v10, v10, v12
  v_cvt_pk_bf16_f32 v9, v9, v10
  ds_write_b32 v4, v9
  s_waitcnt lgkmcnt(0)
  ds_read_b128 v[16:19], v7 offset:0
  ds_read_b128 v[20:23], v7 offset:64
  ds_read_b128 v[24:27], v7 offset:128
  ds_read_b128 v[28:31], v7 offset:192
  v_and_b32 v10, 31, v1
  s_lshr_b32 s40, s36, 4
  s_and_b32 s41, s36, 15
  s_lshl_b32 s41, s41, 5
  v_add_u32 v10, s41, v10
  v_lshrrev_b32 v15, 8, v10
  v_lshlrev_b32 v15, 8, v15
  v_bfe_u32 v72, v10, 2, 2
  v_lshl_add_u32 v15, v72, 6, v15
  v_bfe_u32 v72, v10, 4, 4
  v_lshl_add_u32 v15, v72, 2, v15
  v_and_b32 v72, 3, v10
  v_add_u32 v15, v15, v72
  v_bfe_u32 v72, v10, 3, 2
  v_lshlrev_b32 v73, 7, v72
  v_bfe_u32 v72, v10, 7, 2
  v_lshl_add_u32 v73, v72, 5, v73
  v_and_b32 v72, 7, v10
  v_lshl_add_u32 v73, v72, 2, v73
  v_bfe_u32 v72, v10, 5, 2
  v_add_u32 v73, v73, v72
  s_cmp_lt_u32 s40, 2
  s_cselect_b64 vcc, -1, 0
  v_cndmask_b32 v15, v15, v73, vcc
  s_cmp_eq_u32 s40, 5
  s_cselect_b64 vcc, -1, 0
  v_cndmask_b32 v10, v15, v10, vcc
  v_lshlrev_b32 v10, 2, v10
  s_lshl_b32 s41, s40, 11
  s_add_u32 s41, s41, 2359296
  s_cmp_eq_u32 s40, 1
  s_cselect_b32 s42, 1.0, 0
  s_cmp_eq_u32 s40, 4
  s_cselect_b32 s42, 1.0, s42
  s_lshl_b32 s43, s3, 7
  s_add_u32 s43, s43, 131072
  v_lshl_add_u32 v9, v2, 2, s43
  s_sub_u32 s44, s40, 3
  s_cmp_lt_u32 s44, 2
  s_cselect_b32 s43, 0x3fb8aa3b, 1.0
  s_cmp_eq_u32 s40, 5
  s_cselect_b32 s43, 0x3ef5fdf0, s43
  v_and_b32 v74, 31, v1
  v_lshlrev_b32 v74, 2, v74
  v_add_u32 v74, 131072, v74
  s_waitcnt vmcnt(1)
  s_mov_b64 exec, 0x3fffff
  buffer_load_dword v236, v246, s[8:11], 0 offen
  buffer_load_dword v237, v246, s[12:15], 0 offen
  s_mov_b64 exec, -1
  ds_read_b64_tr_b16 v[32:33], v6 offset:0
  ds_read_b64_tr_b16 v[34:35], v6 offset:256
  ds_read_b64_tr_b16 v[36:37], v6 offset:32
  ds_read_b64_tr_b16 v[38:39], v6 offset:288
  ds_read_b64_tr_b16 v[40:41], v6 offset:2048
  ds_read_b64_tr_b16 v[42:43], v6 offset:2304
  ds_read_b64_tr_b16 v[44:45], v6 offset:2080
  ds_read_b64_tr_b16 v[46:47], v6 offset:2336
  ds_read_b64_tr_b16 v[48:49], v6 offset:4096
  ds_read_b64_tr_b16 v[50:51], v6 offset:4352
  ds_read_b64_tr_b16 v[52:53], v6 offset:4128
  ds_read_b64_tr_b16 v[54:55], v6 offset:4384
  ds_read_b64_tr_b16 v[56:57], v6 offset:6144
  ds_read_b64_tr_b16 v[58:59], v6 offset:6400
  ds_read_b64_tr_b16 v[60:61], v6 offset:6176
  ds_read_b64_tr_b16 v[62:63], v6 offset:6432
  s_waitcnt lgkmcnt(14)
  v_mfma_f32_16x16x32_bf16 v[64:67], v[16:19], v[32:35], 0
  s_waitcnt lgkmcnt(12)
  v_mfma_f32_16x16x32_bf16 v[68:71], v[16:19], v[36:39], 0
  s_waitcnt lgkmcnt(10)
  v_mfma_f32_16x16x32_bf16 v[64:67], v[20:23], v[40:43], v[64:67]
  s_waitcnt lgkmcnt(8)
  v_mfma_f32_16x16x32_bf16 v[68:71], v[20:23], v[44:47], v[68:71]
  s_waitcnt lgkmcnt(6)
  v_mfma_f32_16x16x32_bf16 v[64:67], v[24:27], v[48:51], v[64:67]
  s_waitcnt lgkmcnt(4)
  v_mfma_f32_16x16x32_bf16 v[68:71], v[24:27], v[52:55], v[68:71]
  s_waitcnt lgkmcnt(2)
  v_mfma_f32_16x16x32_bf16 v[64:67], v[28:31], v[56:59], v[64:67]
  s_waitcnt lgkmcnt(0)
  v_mfma_f32_16x16x32_bf16 v[68:71], v[28:31], v[60:63], v[68:71]
  s_mov_b64 exec, 0xffff
  s_nop 4
  ds_write_b32 v9, v64
  s_nop 0
  ds_write_b32 v9, v68 offset:64
  s_mov_b64 exec, -1
  s_waitcnt lgkmcnt(0)
  s_barrier
  s_cmp_lg_u32 s3, 0
  s_cbranch_scc1 .modskip_6
  ds_read_b32 v11, v74
  ds_read_b32 v12, v74 offset:128
  ds_read_b32 v13, v74 offset:256
  ds_read_b32 v14, v74 offset:384
  s_waitcnt lgkmcnt(2)
  v_add_f32 v11, v11, v12
  s_waitcnt lgkmcnt(0)
  v_add_f32 v13, v13, v14
  v_add_f32 v11, v11, v13
  v_cvt_pk_bf16_f32 v11, v11, v11
  v_lshlrev_b32 v11, 16, v11
  v_add_f32 v11, s42, v11
  v_cvt_pk_bf16_f32 v11, v11, v11
  v_lshlrev_b32 v11, 16, v11
  v_mul_f32 v11, s43, v11
  s_mov_b32 exec_hi, 0
  buffer_store_dword v11, v10, s[32:35], s41 offen sc1
  s_mov_b64 exec, -1
.modskip_6:
  s_waitcnt lgkmcnt(0)
  s_mul_i32 s64, s64, 0x9e3779b1
  s_add_u32 s64, s64, 0x7f4a7c15
  s_lshl_b32 s62, s2, 6
  s_add_u32 s62, s62, 14684160
  s_waitcnt vmcnt(0) lgkmcnt(0)
  s_barrier
  s_cmp_lg_u32 s3, 0
  s_cbranch_scc1 .fs_7
  v_mov_b32 v250, 0
  v_mov_b32 v251, s64
  s_mov_b64 exec, 1
  buffer_store_dword v251, v250, s[32:35], s62 offen sc1
  s_mov_b64 exec, -1
.fs_7:
  s_branch .k1end_4
.k1idle_3:
  s_mov_b32 s6, 2097152
  s_mov_b32 s7, 0x20000
  s_mov_b32 s22, 1024
  s_mov_b32 s23, 0x20000
  s_waitcnt lgkmcnt(0)
  s_getpc_b64 s[72:73]
  s_and_b32 s72, s72, 0xffffff00
  s_lshr_b32 s74, s2, 3
  s_lshl_b32 s74, s74, 2
  s_add_u32 s74, s74, s3
  s_and_b32 s74, s74, 15
  s_lshl_b32 s74, s74, 11
  v_and_b32 v250, 15, v0
  v_lshlrev_b32 v250, 7, v250
  v_add_u32 v250, s74, v250
  v_min_u32 v250, .Lend-adaLN_cond__spectral_fnet__swiglu_ffn__prompt_kernel, v250
  global_load_dword v249, v250, s[72:73]
  s_mov_b32 s10, 1409024
  s_mov_b32 s11, 0x20000
  s_mov_b32 s14, 1409024
  s_mov_b32 s15, 0x20000
  s_mov_b32 s18, 1409024
  s_mov_b32 s19, 0x20000
  s_mov_b32 s30, 2097152
  s_mov_b32 s31, 0x20000
  s_mov_b32 s34, 16777216
  s_mov_b32 s35, 0x20000
  s_add_u32 s72, s32, 14680064
  s_addc_u32 s73, s33, 0
  s_load_dword s64, s[72:73], 0
  s_and_b32 s72, s2, 1
  s_lshl_b32 s72, s72, 3
  s_lshr_b32 s73, s2, 5
  s_add_u32 s72, s72, s73
  s_mul_i32 s66, s72, 192
  s_cmp_eq_u32 s72, 15
  s_cselect_b32 s66, 0x200000, s66
  s_mul_i32 s67, s3, 3072
  s_mul_i32 s72, s3, 192
  s_mov_b32 s73, 0x15555556
  v_add_u32 v240, s72, v1
  v_add_u32 v240, 0, v240
  v_mul_hi_u32 v244, v240, s73
  v_mul_u32_u24 v245, 12, v244
  v_sub_u32 v240, v240, v245
  v_lshlrev_b32 v240, 4, v240
  v_mul_u32_u24 v244, 2752, v244
  v_add_u32 v240, v240, v244
  v_add_u32 v241, s72, v1
  v_add_u32 v241, 64, v241
  v_mul_hi_u32 v244, v241, s73
  v_mul_u32_u24 v245, 12, v244
  v_sub_u32 v241, v241, v245
  v_lshlrev_b32 v241, 4, v241
  v_mul_u32_u24 v244, 2752, v244
  v_add_u32 v241, v241, v244
  v_add_u32 v242, s72, v1
  v_add_u32 v242, 128, v242
  v_mul_hi_u32 v244, v242, s73
  v_mul_u32_u24 v245, 12, v244
  v_sub_u32 v242, v242, v245
  v_lshlrev_b32 v242, 4, v242
  v_mul_u32_u24 v244, 2752, v244
  v_add_u32 v242, v242, v244
  s_lshl_b32 s70, s2, 2
  s_add_u32 s70, s70, s3
  s_and_b32 s70, s70, 511
  s_mul_i32 s70, s70, 22
  v_min_u32 v246, 21, v1
  v_add_u32 v246, s70, v246
  v_lshlrev_b32 v246, 7, v246
  s_waitcnt lgkmcnt(0)
  s_mul_i32 s64, s64, 0x9e3779b1
  s_add_u32 s64, s64, 0x7f4a7c15
  s_lshl_b32 s62, s2, 6
  s_add_u32 s62, s62, 14684160
  s_waitcnt vmcnt(63) lgkmcnt(0)
  s_barrier
  s_cmp_lg_u32 s3, 0
  s_cbranch_scc1 .fs_8
  v_mov_b32 v250, 0
  v_mov_b32 v251, s64
  s_mov_b64 exec, 1
  buffer_store_dword v251, v250, s[32:35], s62 offen sc1
  s_mov_b64 exec, -1
.fs_8:
  s_mov_b64 exec, 0x3fffff
  buffer_load_dword v236, v246, s[8:11], 0 offen
  buffer_load_dword v237, v246, s[12:15], 0 offen
  s_mov_b64 exec, -1
.k1end_4:
  s_and_b32 s36, s2, 7
  s_bfe_u32 s37, s2, 0x20003
  s_lshl_b32 s37, s37, 3
  s_add_u32 s36, s36, s37
  s_lshr_b32 s37, s2, 5
  s_sub_u32 s39, 64, s36
  s_cmp_eq_u32 s36, 0
  s_cselect_b32 s39, 32, s39
  s_cselect_b64 s[40:41], -1, 0
  s_lshl_b32 s42, s37, 2
  s_add_u32 s43, s42, s3
  s_lshl_b32 s43, s43, 6
  s_add_u32 s44, s43, s36
  s_add_u32 s45, s43, s39
  s_lshl_b32 s44, s44, 10
  s_lshl_b32 s45, s45, 10
  v_lshlrev_b32 v4, 5, v2
  v_lshl_add_u32 v4, v3, 3, v4
  buffer_load_dwordx2 v[128:129], v4, s[4:7], s44 offen offset:0
  buffer_load_dwordx2 v[130:131], v4, s[4:7], s44 offen offset:512
  buffer_load_dwordx2 v[132:133], v4, s[4:7], s45 offen offset:0
  buffer_load_dwordx2 v[134:135], v4, s[4:7], s45 offen offset:512
  v_lshrrev_b32 v5, 2, v2
  v_add_u32 v5, s42, v5
  v_lshlrev_b32 v5, 6, v5
  v_and_b32 v6, 2, v2
  v_cmp_ne_u32 vcc, 0, v6
  v_mov_b32 v7, s36
  v_mov_b32 v8, s39
  v_cndmask_b32 v7, v7, v8, vcc
  v_add_u32 v5, v5, v7
  v_cvt_f32_u32 v5, v5
  v_mul_f32 v5, 0x3a000000, v5
  v_and_b32 v6, 1, v2
  v_cvt_f32_u32 v6, v6
  v_mul_f32 v6, 0x3e800000, v6
  v_mov_b32 v7, 0xbe800000
  v_mov_b32 v8, 0x3e800000
  v_cndmask_b32 v7, v7, v8, vcc
  v_cndmask_b32 v7, v7, 0, s[40:41]
  v_add_f32 v7, v7, v6
  v_cndmask_b32 v8, 1.0, 0, vcc
  v_cndmask_b32 v9, 0, 1.0, vcc
  v_cndmask_b32 v8, 1.0, v8, s[40:41]
  v_cndmask_b32 v9, 1.0, v9, s[40:41]
  v_lshlrev_b32 v10, 2, v3
  v_cvt_f32_u32 v10, v10
  v_add_f32 v72, 0x00000000, v10
  v_add_f32 v73, 0x3f800000, v10
  v_add_f32 v74, 0x40000000, v10
  v_add_f32 v75, 0x40400000, v10
  v_add_f32 v76, 0x41800000, v10
  v_add_f32 v77, 0x41880000, v10
  v_add_f32 v78, 0x41900000, v10
  v_add_f32 v79, 0x41980000, v10
  v_fma_f32 v64, v72, v5, v6
  v_fma_f32 v65, v72, v5, v7
  v_fma_f32 v66, v73, v5, v6
  v_fma_f32 v67, v73, v5, v7
  v_fma_f32 v68, v74, v5, v6
  v_fma_f32 v69, v74, v5, v7
  v_fma_f32 v70, v75, v5, v6
  v_fma_f32 v71, v75, v5, v7
  v_cos_f32 v64, v64
  v_cos_f32 v65, v65
  v_cos_f32 v66, v66
  v_cos_f32 v67, v67
  v_cos_f32 v68, v68
  v_cos_f32 v69, v69
  v_cos_f32 v70, v70
  v_cos_f32 v71, v71
  v_pk_mul_f32 v[64:65], v[64:65], v[8:9]
  v_cvt_pk_bf16_f32 v16, v64, v65
  v_pk_mul_f32 v[66:67], v[66:67], v[8:9]
  v_cvt_pk_bf16_f32 v17, v66, v67
  v_pk_mul_f32 v[68:69], v[68:69], v[8:9]
  v_cvt_pk_bf16_f32 v18, v68, v69
  v_pk_mul_f32 v[70:71], v[70:71], v[8:9]
  v_cvt_pk_bf16_f32 v19, v70, v71
  v_fma_f32 v64, v76, v5, v6
  v_fma_f32 v65, v76, v5, v7
  v_fma_f32 v66, v77, v5, v6
  v_fma_f32 v67, v77, v5, v7
  v_fma_f32 v68, v78, v5, v6
  v_fma_f32 v69, v78, v5, v7
  v_fma_f32 v70, v79, v5, v6
  v_fma_f32 v71, v79, v5, v7
  v_cos_f32 v64, v64
  v_cos_f32 v65, v65
  v_cos_f32 v66, v66
  v_cos_f32 v67, v67
  v_cos_f32 v68, v68
  v_cos_f32 v69, v69
  v_cos_f32 v70, v70
  v_cos_f32 v71, v71
  v_pk_mul_f32 v[64:65], v[64:65], v[8:9]
  v_cvt_pk_bf16_f32 v20, v64, v65
  v_pk_mul_f32 v[66:67], v[66:67], v[8:9]
  v_cvt_pk_bf16_f32 v21, v66, v67
  v_pk_mul_f32 v[68:69], v[68:69], v[8:9]
  v_cvt_pk_bf16_f32 v22, v68, v69
  v_pk_mul_f32 v[70:71], v[70:71], v[8:9]
  v_cvt_pk_bf16_f32 v23, v70, v71
  v_cvt_f32_u32 v12, v2
  v_mul_f32 v13, 0x3d800000, v12
  v_mul_f32 v64, v72, v13
  v_mul_f32 v65, v73, v13
  v_mul_f32 v66, v74, v13
  v_mul_f32 v67, v75, v13
  v_sin_f32 v68, v64
  v_sin_f32 v69, v65
  v_sin_f32 v70, v66
  v_sin_f32 v71, v67
  v_cos_f32 v64, v64
  v_cos_f32 v65, v65
  v_cos_f32 v66, v66
  v_cos_f32 v67, v67
  v_cvt_pk_bf16_f32 v24, v64, v65
  v_cvt_pk_bf16_f32 v26, v68, v69
  v_cvt_pk_bf16_f32 v25, v66, v67
  v_cvt_pk_bf16_f32 v27, v70, v71
  v_mul_f32 v13, 0x3b000000, v12
  s_lshl_b32 s46, s3, 3
  v_cvt_f32_u32 v14, s46
  v_add_f32 v11, 0x00000000, v14
  v_mul_f32 v64, v11, v13
  v_add_f32 v11, 0x3f800000, v14
  v_mul_f32 v65, v11, v13
  v_add_f32 v11, 0x40000000, v14
  v_mul_f32 v66, v11, v13
  v_add_f32 v11, 0x40400000, v14
  v_mul_f32 v67, v11, v13
  v_add_f32 v11, 0x40800000, v14
  v_mul_f32 v68, v11, v13
  v_add_f32 v11, 0x40a00000, v14
  v_mul_f32 v69, v11, v13
  v_add_f32 v11, 0x40c00000, v14
  v_mul_f32 v70, v11, v13
  v_add_f32 v11, 0x40e00000, v14
  v_mul_f32 v71, v11, v13
  v_cos_f32 v28, v64
  v_sin_f32 v29, v64
  v_cos_f32 v30, v65
  v_sin_f32 v31, v65
  v_cos_f32 v32, v66
  v_sin_f32 v33, v66
  v_cos_f32 v34, v67
  v_sin_f32 v35, v67
  v_cos_f32 v36, v68
  v_sin_f32 v37, v68
  v_cos_f32 v38, v69
  v_sin_f32 v39, v69
  v_cos_f32 v40, v70
  v_sin_f32 v41, v70
  v_cos_f32 v42, v71
  v_sin_f32 v43, v71
  v_add_f32 v13, 0x00000000, v12
  v_mul_f32 v13, 0x3d000000, v13
  v_mul_f32 v64, v72, v13
  v_mul_f32 v65, v73, v13
  v_mul_f32 v66, v74, v13
  v_mul_f32 v67, v75, v13
  v_sin_f32 v68, v64
  v_sin_f32 v69, v65
  v_sin_f32 v70, v66
  v_sin_f32 v71, v67
  v_cos_f32 v64, v64
  v_cos_f32 v65, v65
  v_cos_f32 v66, v66
  v_cos_f32 v67, v67
  v_cvt_pk_bf16_f32 v44, v64, v68
  v_cvt_pk_bf16_f32 v45, v65, v69
  v_cvt_pk_bf16_f32 v46, v66, v70
  v_cvt_pk_bf16_f32 v47, v67, v71
  v_mul_f32 v64, v76, v13
  v_mul_f32 v65, v77, v13
  v_mul_f32 v66, v78, v13
  v_mul_f32 v67, v79, v13
  v_sin_f32 v68, v64
  v_sin_f32 v69, v65
  v_sin_f32 v70, v66
  v_sin_f32 v71, v67
  v_cos_f32 v64, v64
  v_cos_f32 v65, v65
  v_cos_f32 v66, v66
  v_cos_f32 v67, v67
  v_cvt_pk_bf16_f32 v48, v64, v68
  v_cvt_pk_bf16_f32 v49, v65, v69
  v_cvt_pk_bf16_f32 v50, v66, v70
  v_cvt_pk_bf16_f32 v51, v67, v71
  v_add_f32 v13, 0x41800000, v12
  v_mul_f32 v13, 0x3d000000, v13
  v_mul_f32 v64, v72, v13
  v_mul_f32 v65, v73, v13
  v_mul_f32 v66, v74, v13
  v_mul_f32 v67, v75, v13
  v_sin_f32 v68, v64
  v_sin_f32 v69, v65
  v_sin_f32 v70, v66
  v_sin_f32 v71, v67
  v_cos_f32 v64, v64
  v_cos_f32 v65, v65
  v_cos_f32 v66, v66
  v_cos_f32 v67, v67
  v_cvt_pk_bf16_f32 v52, v64, v68
  v_cvt_pk_bf16_f32 v53, v65, v69
  v_cvt_pk_bf16_f32 v54, v66, v70
  v_cvt_pk_bf16_f32 v55, v67, v71
  v_mul_f32 v64, v76, v13
  v_mul_f32 v65, v77, v13
  v_mul_f32 v66, v78, v13
  v_mul_f32 v67, v79, v13
  v_sin_f32 v68, v64
  v_sin_f32 v69, v65
  v_sin_f32 v70, v66
  v_sin_f32 v71, v67
  v_cos_f32 v64, v64
  v_cos_f32 v65, v65
  v_cos_f32 v66, v66
  v_cos_f32 v67, v67
  v_cvt_pk_bf16_f32 v56, v64, v68
  v_cvt_pk_bf16_f32 v57, v65, v69
  v_cvt_pk_bf16_f32 v58, v66, v70
  v_cvt_pk_bf16_f32 v59, v67, v71
  v_mul_u32_u24 v5, 8192, v3
  v_lshl_add_u32 v5, v2, 4, v5
  s_mul_i32 s46, s36, 65536
  s_mul_i32 s47, s3, 512
  s_add_u32 s46, s46, s47
  s_add_u32 s46, s46, 0
  s_add_u32 s47, s46, 4096
  s_add_u32 s48, s46, 32768
  s_add_u32 s49, s46, 36864
  s_add_u32 s76, s46, 2048
  s_add_u32 s77, s47, 2048
  s_add_u32 s78, s48, 2048
  s_add_u32 s79, s49, 2048
  v_lshlrev_b32 v6, 7, v3
  s_lshl_b32 s50, s3, 9
  s_add_u32 s50, s50, 2359296
  s_cmp_eq_u32 s2, 0
  s_cselect_b32 s59, s50, 16777216
  v_lshlrev_b32 v7, 4, v1
  v_lshl_add_u32 v8, v3, 5, v2
  v_mul_u32_u24 v8, 144, v8
  s_lshl_b32 s51, s3, 5
  s_add_u32 s51, s51, 123200
  v_add_u32 v8, s51, v8
  v_mul_u32_u24 v9, 144, v2
  v_lshl_add_u32 v9, v3, 4, v9
  s_mul_i32 s51, s3, 4608
  s_add_u32 s51, s51, 123200
  v_add_u32 v9, s51, v9
  s_mul_i32 s51, s3, 2176
  s_add_u32 s51, s51, 141632
  v_bfe_u32 v10, v2, 2, 1
  v_mul_u32_u24 v10, 16, v10
  v_xor_b32 v10, v10, v4
  v_add_u32 v10, s51, v10
  v_and_b32 v11, 7, v0
  v_lshrrev_b32 v12, 3, v0
  v_bfe_u32 v14, v12, 3, 1
  v_mul_u32_u24 v14, 1, v14
  v_xor_b32 v14, v14, v12
  v_mul_u32_u24 v13, 1088, v11
  v_lshl_add_u32 v13, v14, 4, v13
  v_add_u32 v13, 141632, v13
  v_lshlrev_b32 v11, 4, v11
  v_lshl_add_u32 v11, v12, 9, v11
  s_lshl_b32 s51, s36, 3
  s_add_u32 s51, s51, s37
  s_lshl_b32 s52, s51, 13
  s_lshl_b32 s53, s3, 11
  s_add_u32 s52, s52, s53
  s_add_u32 s52, s52, 5242880
  s_add_u32 s53, s52, 1024
  s_lshr_b32 s54, s51, 2
  s_lshl_b32 s54, s54, 15
  s_and_b32 s55, s51, 3
  s_lshl_b32 s55, s55, 7
  s_add_u32 s54, s54, s55
  s_add_u32 s54, s54, 3145728
  s_add_u32 s55, s54, 16384
  s_mov_b32 s56, 2363392
  s_mov_b32 s57, 2365440
  s_mov_b32 s58, 2367488
  s_lshl_b32 s62, s51, 7
  s_add_u32 s62, s62, 14745600
  v_lshlrev_b32 v250, 6, v1
  s_mov_b32 s63, 14684160
  s_cmp_eq_u32 s3, 0
  s_cbranch_scc1 .p0_11
  s_sub_u32 s72, s3, 1
  s_lshl_b32 s96, s72, 12
  s_lshl_b32 s72, s72, 8
  s_mov_b32 s73, 0x15555556
  v_add_u32 v224, s72, v1
  v_add_u32 v224, 0, v224
  v_mul_hi_u32 v244, v224, s73
  v_mul_u32_u24 v245, 12, v244
  v_sub_u32 v224, v224, v245
  v_lshlrev_b32 v224, 4, v224
  v_mul_u32_u24 v244, 2752, v244
  v_add_u32 v224, v224, v244
  v_add_u32 v225, s72, v1
  v_add_u32 v225, 64, v225
  v_mul_hi_u32 v244, v225, s73
  v_mul_u32_u24 v245, 12, v244
  v_sub_u32 v225, v225, v245
  v_lshlrev_b32 v225, 4, v225
  v_mul_u32_u24 v244, 2752, v244
  v_add_u32 v225, v225, v244
  v_add_u32 v226, s72, v1
  v_add_u32 v226, 128, v226
  v_mul_hi_u32 v244, v226, s73
  v_mul_u32_u24 v245, 12, v244
  v_sub_u32 v226, v226, v245
  v_lshlrev_b32 v226, 4, v226
  v_mul_u32_u24 v244, 2752, v244
  v_add_u32 v226, v226, v244
  v_add_u32 v227, s72, v1
  v_add_u32 v227, 192, v227
  v_mul_hi_u32 v244, v227, s73
  v_mul_u32_u24 v245, 12, v244
  v_sub_u32 v227, v227, v245
  v_lshlrev_b32 v227, 4, v227
  v_mul_u32_u24 v244, 2752, v244
  v_add_u32 v227, v227, v244
  s_add_u32 s75, s66, 0
  s_add_u32 m0, s96, 0
  s_nop 0
  buffer_load_dwordx4 v224, s[8:11], s75 offen lds
  s_add_u32 m0, s96, 1024
  s_nop 0
  buffer_load_dwordx4 v225, s[8:11], s75 offen lds
  s_add_u32 m0, s96, 2048
  s_nop 0
  buffer_load_dwordx4 v226, s[8:11], s75 offen lds
  s_add_u32 m0, s96, 3072
  s_nop 0
  buffer_load_dwordx4 v227, s[8:11], s75 offen lds
  s_add_u32 m0, s96, 12320
  s_nop 0
  buffer_load_dwordx4 v224, s[12:15], s75 offen lds
  s_add_u32 m0, s96, 13344
  s_nop 0
  buffer_load_dwordx4 v225, s[12:15], s75 offen lds
  s_add_u32 m0, s96, 14368
  s_nop 0
  buffer_load_dwordx4 v226, s[12:15], s75 offen lds
  s_add_u32 m0, s96, 15392
  s_nop 0
  buffer_load_dwordx4 v227, s[12:15], s75 offen lds
  s_add_u32 s75, s66, 176128
  s_add_u32 m0, s96, 24640
  s_nop 0
  buffer_load_dwordx4 v224, s[8:11], s75 offen lds
  s_add_u32 m0, s96, 25664
  s_nop 0
  buffer_load_dwordx4 v225, s[8:11], s75 offen lds
  s_add_u32 m0, s96, 26688
  s_nop 0
  buffer_load_dwordx4 v226, s[8:11], s75 offen lds
  s_add_u32 m0, s96, 27712
  s_nop 0
  buffer_load_dwordx4 v227, s[8:11], s75 offen lds
  s_add_u32 m0, s96, 36960
  s_nop 0
  buffer_load_dwordx4 v224, s[12:15], s75 offen lds
  s_add_u32 m0, s96, 37984
  s_nop 0
  buffer_load_dwordx4 v225, s[12:15], s75 offen lds
  s_add_u32 m0, s96, 39008
  s_nop 0
  buffer_load_dwordx4 v226, s[12:15], s75 offen lds
  s_add_u32 m0, s96, 40032
  s_nop 0
  buffer_load_dwordx4 v227, s[12:15], s75 offen lds
  s_add_u32 s75, s66, 352256
  s_add_u32 m0, s96, 49280
  s_nop 0
  buffer_load_dwordx4 v224, s[8:11], s75 offen lds
  s_add_u32 m0, s96, 50304
  s_nop 0
  buffer_load_dwordx4 v225, s[8:11], s75 offen lds
  s_add_u32 m0, s96, 51328
  s_nop 0
  buffer_load_dwordx4 v226, s[8:11], s75 offen lds
  s_add_u32 m0, s96, 52352
  s_nop 0
  buffer_load_dwordx4 v227, s[8:11], s75 offen lds
  s_add_u32 m0, s96, 61600
  s_nop 0
  buffer_load_dwordx4 v224, s[12:15], s75 offen lds
  s_add_u32 m0, s96, 62624
  s_nop 0
  buffer_load_dwordx4 v225, s[12:15], s75 offen lds
  s_add_u32 m0, s96, 63648
  s_nop 0
  buffer_load_dwordx4 v226, s[12:15], s75 offen lds
  s_add_u32 m0, s96, 64672
  s_nop 0
  buffer_load_dwordx4 v227, s[12:15], s75 offen lds
  s_branch .pj_12
.p0_11:
  s_mov_b32 s65, 0
  v_lshlrev_b32 v250, 6, v1
  s_add_u32 s72, s63, 4096
  s_add_u32 s73, s63, 8192
  s_add_u32 s74, s63, 12288
  s_mov_b64 s[84:85], -1
  s_mov_b64 s[86:87], -1
  s_mov_b64 s[88:89], 0
  s_mov_b64 s[90:91], 0
.pl_10:
  s_mov_b64 exec, s[84:85]
  s_cbranch_execz .ps_13
  buffer_load_dword v252, v250, s[32:35], s63 offen sc1
.ps_13:
  s_mov_b64 exec, s[86:87]
  s_cbranch_execz .ps_14
  buffer_load_dword v253, v250, s[32:35], s72 offen sc1
.ps_14:
  s_add_u32 s65, s65, 1
  s_waitcnt vmcnt(0)
  s_mov_b64 exec, s[84:85]
  v_cmp_ne_u32 s[84:85], s64, v252
  s_mov_b64 exec, s[86:87]
  v_cmp_ne_u32 s[86:87], s64, v253
  s_nop 0
  s_or_b64 s[92:93], s[84:85], s[86:87]
  s_or_b64 s[94:95], s[88:89], s[90:91]
  s_cmp_ge_u32 s65, 400000
  s_cbranch_scc1 .pk_9
  s_or_b64 s[92:93], s[92:93], s[94:95]
  s_cbranch_scc0 .pk_9
  s_branch .pl_10
.pk_9:
  s_mov_b64 exec, -1
.pj_12:
  s_barrier
.Lk2code:
  s_cmp_lg_u32 s2, 0
  s_cbranch_scc1 .k2sl_15
.k2sl_15:
  s_cmp_lg_u32 s3, 0
  s_cbranch_scc1 .k2m0_16
  buffer_load_dword v254, v250, s[32:35], s73 offen sc1
  buffer_load_dword v255, v250, s[32:35], s74 offen sc1
.k2m0_16:
  buffer_load_dwordx4 v[64:67], v5, s[32:35], s46 offen offset:0 sc1
  buffer_load_dwordx4 v[68:71], v5, s[32:35], s76 offen offset:0 sc1
  buffer_load_dwordx4 v[72:75], v5, s[32:35], s47 offen offset:0 sc1
  buffer_load_dwordx4 v[76:79], v5, s[32:35], s77 offen offset:0 sc1
  buffer_load_dwordx4 v[96:99], v5, s[32:35], s48 offen offset:0 sc1
  buffer_load_dwordx4 v[100:103], v5, s[32:35], s78 offen offset:0 sc1
  buffer_load_dwordx4 v[104:107], v5, s[32:35], s49 offen offset:0 sc1
  buffer_load_dwordx4 v[108:111], v5, s[32:35], s79 offen offset:0 sc1
  buffer_load_dwordx4 v[80:83], v5, s[32:35], s46 offen offset:256 sc1
  buffer_load_dwordx4 v[84:87], v5, s[32:35], s76 offen offset:256 sc1
  buffer_load_dwordx4 v[88:91], v5, s[32:35], s47 offen offset:256 sc1
  buffer_load_dwordx4 v[92:95], v5, s[32:35], s77 offen offset:256 sc1
  buffer_load_dwordx4 v[112:115], v5, s[32:35], s48 offen offset:256 sc1
  buffer_load_dwordx4 v[116:119], v5, s[32:35], s78 offen offset:256 sc1
  buffer_load_dwordx4 v[120:123], v5, s[32:35], s49 offen offset:256 sc1
  buffer_load_dwordx4 v[124:127], v5, s[32:35], s79 offen offset:256 sc1
  s_cmp_lg_u32 s3, 0
  s_cbranch_scc1 .k2m1_17
  s_mov_b32 s65, 0
  s_waitcnt vmcnt(16)
.k2ml_18:
  v_xor_b32 v254, s64, v254
  v_xor_b32 v255, s64, v255
  v_or_b32 v254, v254, v255
  v_cmp_ne_u32 vcc, 0, v254
  s_add_u32 s65, s65, 1
  s_cmp_ge_u32 s65, 400000
  s_cbranch_scc1 .k2m1_17
  s_cbranch_vccz .k2m1_17
  buffer_load_dword v254, v250, s[32:35], s73 offen sc1
  buffer_load_dword v255, v250, s[32:35], s74 offen sc1
  s_waitcnt vmcnt(0)
  s_branch .k2ml_18
.k2m1_17:
  s_barrier
  s_cmp_lg_u32 s2, 0
  s_cbranch_scc1 .k2s1_19
  buffer_load_dwordx4 a[0:3], v6, s[32:35], s50 offen offset:0 sc1
  buffer_load_dwordx4 a[4:7], v6, s[32:35], s50 offen offset:16 sc1
  buffer_load_dwordx4 a[8:11], v6, s[32:35], s50 offen offset:32 sc1
  buffer_load_dwordx4 a[12:15], v6, s[32:35], s50 offen offset:48 sc1
  buffer_load_dwordx4 a[16:19], v6, s[32:35], s50 offen offset:64 sc1
  buffer_load_dwordx4 a[20:23], v6, s[32:35], s50 offen offset:80 sc1
  buffer_load_dwordx4 a[24:27], v6, s[32:35], s50 offen offset:96 sc1
  buffer_load_dwordx4 a[28:31], v6, s[32:35], s50 offen offset:112 sc1
.k2s1_19:
  buffer_load_dwordx4 v[136:139], v6, s[32:35], s50 offen offset:2048 sc1
  buffer_load_dwordx4 v[140:143], v6, s[32:35], s50 offen offset:2064 sc1
  buffer_load_dwordx4 v[144:147], v6, s[32:35], s50 offen offset:2080 sc1
  buffer_load_dwordx4 v[148:151], v6, s[32:35], s50 offen offset:2096 sc1
  buffer_load_dwordx4 v[152:155], v6, s[32:35], s50 offen offset:2112 sc1
  buffer_load_dwordx4 v[156:159], v6, s[32:35], s50 offen offset:2128 sc1
  buffer_load_dwordx4 v[160:163], v6, s[32:35], s50 offen offset:2144 sc1
  buffer_load_dwordx4 v[164:167], v6, s[32:35], s50 offen offset:2160 sc1
  buffer_load_dwordx4 v[168:171], v7, s[32:35], s56 offen offset:0 sc1
  buffer_load_dwordx4 v[172:175], v7, s[32:35], s56 offen offset:1024 sc1
  buffer_load_dwordx4 v[176:179], v7, s[32:35], s58 offen offset:0 sc1
  buffer_load_dwordx4 v[180:183], v7, s[32:35], s58 offen offset:1024 sc1
  buffer_load_dwordx4 v[184:187], v7, s[32:35], s57 offen offset:0 sc1
  buffer_load_dwordx4 v[188:191], v7, s[32:35], s57 offen offset:1024 sc1
  s_waitcnt vmcnt(29)
  v_lshlrev_b32 v224, 16, v128
  v_and_b32 v225, 0xffff0000, v128
  v_lshlrev_b32 v226, 16, v129
  v_and_b32 v227, 0xffff0000, v129
  v_lshlrev_b32 v228, 16, v130
  v_and_b32 v229, 0xffff0000, v130
  v_lshlrev_b32 v230, 16, v131
  v_and_b32 v231, 0xffff0000, v131
  v_lshlrev_b32 v232, 16, v132
  v_and_b32 v233, 0xffff0000, v132
  v_lshlrev_b32 v234, 16, v133
  v_and_b32 v235, 0xffff0000, v133
  v_lshlrev_b32 v236, 16, v134
  v_and_b32 v237, 0xffff0000, v134
  v_lshlrev_b32 v238, 16, v135
  v_and_b32 v239, 0xffff0000, v135
  s_waitcnt vmcnt(28)
  v_swap_b32 v65, v68
  s_waitcnt vmcnt(27)
  v_swap_b32 v66, v72
  s_waitcnt vmcnt(26)
  v_swap_b32 v67, v76
  v_swap_b32 v70, v73
  v_swap_b32 v71, v77
  v_swap_b32 v75, v78
  s_waitcnt vmcnt(24)
  v_swap_b32 v97, v100
  s_waitcnt vmcnt(23)
  v_swap_b32 v98, v104
  s_waitcnt vmcnt(22)
  v_swap_b32 v99, v108
  v_swap_b32 v102, v105
  v_swap_b32 v103, v109
  v_swap_b32 v107, v110
  v_mfma_f32_16x16x32_bf16 v[192:195], v[64:67], v[16:19], 0
  s_add_u32 m0, s67, 73920
  s_add_u32 s75, s66, 528384
  buffer_load_dwordx4 v240, s[8:11], s75 offen  lds
  v_mfma_f32_16x16x32_bf16 v[192:195], v[96:99], v[20:23], v[192:195]
  s_add_u32 m0, s67, 74944
  s_nop 0
  buffer_load_dwordx4 v241, s[8:11], s75 offen  lds
  v_mfma_f32_16x16x32_bf16 v[196:199], v[68:71], v[16:19], 0
  s_add_u32 m0, s67, 75968
  s_nop 0
  buffer_load_dwordx4 v242, s[8:11], s75 offen  lds
  v_mfma_f32_16x16x32_bf16 v[196:199], v[100:103], v[20:23], v[196:199]
  s_add_u32 m0, s67, 86240
  s_nop 0
  buffer_load_dwordx4 v240, s[12:15], s75 offen  lds
  v_mfma_f32_16x16x32_bf16 v[200:203], v[72:75], v[16:19], 0
  s_add_u32 m0, s67, 87264
  s_nop 0
  buffer_load_dwordx4 v241, s[12:15], s75 offen  lds
  v_mfma_f32_16x16x32_bf16 v[200:203], v[104:107], v[20:23], v[200:203]
  s_add_u32 m0, s67, 88288
  s_nop 0
  buffer_load_dwordx4 v242, s[12:15], s75 offen  lds
  v_mfma_f32_16x16x32_bf16 v[204:207], v[76:79], v[16:19], 0
  v_mfma_f32_16x16x32_bf16 v[204:207], v[108:111], v[20:23], v[204:207]
  s_waitcnt vmcnt(26)
  v_swap_b32 v81, v84
  s_waitcnt vmcnt(25)
  v_swap_b32 v82, v88
  s_waitcnt vmcnt(24)
  v_swap_b32 v83, v92
  v_swap_b32 v86, v89
  v_swap_b32 v87, v93
  v_swap_b32 v91, v94
  s_waitcnt vmcnt(22)
  v_swap_b32 v113, v116
  s_waitcnt vmcnt(21)
  v_swap_b32 v114, v120
  s_waitcnt vmcnt(20)
  v_swap_b32 v115, v124
  v_swap_b32 v118, v121
  v_swap_b32 v119, v125
  v_swap_b32 v123, v126
  v_mfma_f32_16x16x32_bf16 v[208:211], v[80:83], v[16:19], 0
  v_mfma_f32_16x16x32_bf16 v[208:211], v[112:115], v[20:23], v[208:211]
  v_mfma_f32_16x16x32_bf16 v[212:215], v[84:87], v[16:19], 0
  v_mfma_f32_16x16x32_bf16 v[212:215], v[116:119], v[20:23], v[212:215]
  v_mfma_f32_16x16x32_bf16 v[216:219], v[88:91], v[16:19], 0
  v_mfma_f32_16x16x32_bf16 v[216:219], v[120:123], v[20:23], v[216:219]
  v_mfma_f32_16x16x32_bf16 v[220:223], v[92:95], v[16:19], 0
  v_mfma_f32_16x16x32_bf16 v[220:223], v[124:127], v[20:23], v[220:223]
  s_waitcnt vmcnt(19)
  v_pk_mul_f32 v[192:193], v[192:193], v[136:137]
  v_pk_mul_f32 v[194:195], v[194:195], v[138:139]
  s_waitcnt vmcnt(18)
  v_pk_mul_f32 v[196:197], v[196:197], v[140:141]
  v_pk_mul_f32 v[198:199], v[198:199], v[142:143]
  s_waitcnt vmcnt(17)
  v_pk_mul_f32 v[200:201], v[200:201], v[144:145]
  v_pk_mul_f32 v[202:203], v[202:203], v[146:147]
  s_waitcnt vmcnt(16)
  v_pk_mul_f32 v[204:205], v[204:205], v[148:149]
  v_pk_mul_f32 v[206:207], v[206:207], v[150:151]
  s_waitcnt vmcnt(15)
  v_pk_mul_f32 v[208:209], v[208:209], v[152:153]
  v_pk_mul_f32 v[210:211], v[210:211], v[154:155]
  s_waitcnt vmcnt(14)
  v_pk_mul_f32 v[212:213], v[212:213], v[156:157]
  v_pk_mul_f32 v[214:215], v[214:215], v[158:159]
  s_waitcnt vmcnt(13)
  v_pk_mul_f32 v[216:217], v[216:217], v[160:161]
  v_pk_mul_f32 v[218:219], v[218:219], v[162:163]
  s_waitcnt vmcnt(12)
  v_pk_mul_f32 v[220:221], v[220:221], v[164:165]
  v_pk_mul_f32 v[222:223], v[222:223], v[166:167]
  s_cmp_lg_u32 s2, 0
  s_cbranch_scc1 .k2sa_20
  s_mov_b32 s59, 0x45000000
  s_mov_b32 exec_lo, 0x00010001
  s_mov_b32 exec_hi, 0x00010001
  v_accvgpr_read_b32 v80, a0
  v_fma_f32 v192, v80, s59, v192
  v_accvgpr_read_b32 v80, a1
  v_fma_f32 v193, v80, s59, v193
  v_accvgpr_read_b32 v80, a2
  v_fma_f32 v194, v80, s59, v194
  v_accvgpr_read_b32 v80, a3
  v_fma_f32 v195, v80, s59, v195
  v_accvgpr_read_b32 v80, a4
  v_fma_f32 v196, v80, s59, v196
  v_accvgpr_read_b32 v80, a5
  v_fma_f32 v197, v80, s59, v197
  v_accvgpr_read_b32 v80, a6
  v_fma_f32 v198, v80, s59, v198
  v_accvgpr_read_b32 v80, a7
  v_fma_f32 v199, v80, s59, v199
  v_accvgpr_read_b32 v80, a8
  v_fma_f32 v200, v80, s59, v200
  v_accvgpr_read_b32 v80, a9
  v_fma_f32 v201, v80, s59, v201
  v_accvgpr_read_b32 v80, a10
  v_fma_f32 v202, v80, s59, v202
  v_accvgpr_read_b32 v80, a11
  v_fma_f32 v203, v80, s59, v203
  v_accvgpr_read_b32 v80, a12
  v_fma_f32 v204, v80, s59, v204
  v_accvgpr_read_b32 v80, a13
  v_fma_f32 v205, v80, s59, v205
  v_accvgpr_read_b32 v80, a14
  v_fma_f32 v206, v80, s59, v206
  v_accvgpr_read_b32 v80, a15
  v_fma_f32 v207, v80, s59, v207
  v_accvgpr_read_b32 v80, a16
  v_fma_f32 v208, v80, s59, v208
  v_accvgpr_read_b32 v80, a17
  v_fma_f32 v209, v80, s59, v209
  v_accvgpr_read_b32 v80, a18
  v_fma_f32 v210, v80, s59, v210
  v_accvgpr_read_b32 v80, a19
  v_fma_f32 v211, v80, s59, v211
  v_accvgpr_read_b32 v80, a20
  v_fma_f32 v212, v80, s59, v212
  v_accvgpr_read_b32 v80, a21
  v_fma_f32 v213, v80, s59, v213
  v_accvgpr_read_b32 v80, a22
  v_fma_f32 v214, v80, s59, v214
  v_accvgpr_read_b32 v80, a23
  v_fma_f32 v215, v80, s59, v215
  v_accvgpr_read_b32 v80, a24
  v_fma_f32 v216, v80, s59, v216
  v_accvgpr_read_b32 v80, a25
  v_fma_f32 v217, v80, s59, v217
  v_accvgpr_read_b32 v80, a26
  v_fma_f32 v218, v80, s59, v218
  v_accvgpr_read_b32 v80, a27
  v_fma_f32 v219, v80, s59, v219
  v_accvgpr_read_b32 v80, a28
  v_fma_f32 v220, v80, s59, v220
  v_accvgpr_read_b32 v80, a29
  v_fma_f32 v221, v80, s59, v221
  v_accvgpr_read_b32 v80, a30
  v_fma_f32 v222, v80, s59, v222
  v_accvgpr_read_b32 v80, a31
  v_fma_f32 v223, v80, s59, v223
  s_mov_b64 exec, -1
.k2sa_20:
  v_cvt_pk_bf16_f32 v64, v192, v193
  v_cvt_pk_bf16_f32 v65, v194, v195
  v_cvt_pk_bf16_f32 v66, v196, v197
  v_cvt_pk_bf16_f32 v67, v198, v199
  v_mfma_f32_16x16x16_bf16 v[80:83], v[64:65], v[24:25], 0
  v_mfma_f32_16x16x16_bf16 v[192:195], v[64:65], v[26:27], 0
  v_cvt_pk_bf16_f32 v68, v200, v201
  v_cvt_pk_bf16_f32 v69, v202, v203
  v_mfma_f32_16x16x16_bf16 v[84:87], v[66:67], v[24:25], 0
  v_mfma_f32_16x16x16_bf16 v[196:199], v[66:67], v[26:27], 0
  v_cvt_pk_bf16_f32 v70, v204, v205
  v_cvt_pk_bf16_f32 v71, v206, v207
  v_mfma_f32_16x16x16_bf16 v[88:91], v[68:69], v[24:25], 0
  v_mfma_f32_16x16x16_bf16 v[200:203], v[68:69], v[26:27], 0
  v_cvt_pk_bf16_f32 v72, v208, v209
  v_cvt_pk_bf16_f32 v73, v210, v211
  v_mfma_f32_16x16x16_bf16 v[92:95], v[70:71], v[24:25], 0
  v_mfma_f32_16x16x16_bf16 v[204:207], v[70:71], v[26:27], 0
  v_cvt_pk_bf16_f32 v74, v212, v213
  v_cvt_pk_bf16_f32 v75, v214, v215
  v_mfma_f32_16x16x16_bf16 v[96:99], v[72:73], v[24:25], 0
  v_mfma_f32_16x16x16_bf16 v[208:211], v[72:73], v[26:27], 0
  v_cvt_pk_bf16_f32 v76, v216, v217
  v_cvt_pk_bf16_f32 v77, v218, v219
  v_mfma_f32_16x16x16_bf16 v[100:103], v[74:75], v[24:25], 0
  v_mfma_f32_16x16x16_bf16 v[212:215], v[74:75], v[26:27], 0
  v_cvt_pk_bf16_f32 v78, v220, v221
  v_cvt_pk_bf16_f32 v79, v222, v223
  v_mfma_f32_16x16x16_bf16 v[104:107], v[76:77], v[24:25], 0
  v_mfma_f32_16x16x16_bf16 v[216:219], v[76:77], v[26:27], 0
  v_mfma_f32_16x16x16_bf16 v[108:111], v[78:79], v[24:25], 0
  v_mfma_f32_16x16x16_bf16 v[220:223], v[78:79], v[26:27], 0
  v_pk_add_f32 v[80:81], v[80:81], v[192:193] op_sel:[0,1] op_sel_hi:[1,0] neg_hi:[0,1]
  v_pk_add_f32 v[84:85], v[84:85], v[196:197] op_sel:[0,1] op_sel_hi:[1,0] neg_hi:[0,1]
  v_pk_add_f32 v[88:89], v[88:89], v[200:201] op_sel:[0,1] op_sel_hi:[1,0] neg_hi:[0,1]
  v_pk_add_f32 v[92:93], v[92:93], v[204:205] op_sel:[0,1] op_sel_hi:[1,0] neg_hi:[0,1]
  v_pk_mul_f32 v[192:193], v[80:81], v[28:29] op_sel:[0,0] op_sel_hi:[1,0]
  v_pk_mul_f32 v[196:197], v[84:85], v[30:31] op_sel:[0,0] op_sel_hi:[1,0]
  v_pk_mul_f32 v[200:201], v[88:89], v[32:33] op_sel:[0,0] op_sel_hi:[1,0]
  v_pk_mul_f32 v[204:205], v[92:93], v[34:35] op_sel:[0,0] op_sel_hi:[1,0]
  v_pk_fma_f32 v[192:193], v[80:81], v[28:29], v[192:193] op_sel:[1,1,0] op_sel_hi:[0,1,1] neg_hi:[1,0,0]
  v_pk_fma_f32 v[196:197], v[84:85], v[30:31], v[196:197] op_sel:[1,1,0] op_sel_hi:[0,1,1] neg_hi:[1,0,0]
  v_pk_fma_f32 v[200:201], v[88:89], v[32:33], v[200:201] op_sel:[1,1,0] op_sel_hi:[0,1,1] neg_hi:[1,0,0]
  v_pk_fma_f32 v[204:205], v[92:93], v[34:35], v[204:205] op_sel:[1,1,0] op_sel_hi:[0,1,1] neg_hi:[1,0,0]
  v_cvt_pk_bf16_f32 v112, v192, v193
  v_cvt_pk_bf16_f32 v113, v196, v197
  v_cvt_pk_bf16_f32 v114, v200, v201
  v_cvt_pk_bf16_f32 v115, v204, v205
  ds_write_b128 v8, v[112:115] offset:0
  v_pk_add_f32 v[82:83], v[82:83], v[194:195] op_sel:[0,1] op_sel_hi:[1,0] neg_hi:[0,1]
  v_pk_add_f32 v[86:87], v[86:87], v[198:199] op_sel:[0,1] op_sel_hi:[1,0] neg_hi:[0,1]
  v_pk_add_f32 v[90:91], v[90:91], v[202:203] op_sel:[0,1] op_sel_hi:[1,0] neg_hi:[0,1]
  v_pk_add_f32 v[94:95], v[94:95], v[206:207] op_sel:[0,1] op_sel_hi:[1,0] neg_hi:[0,1]
  v_pk_mul_f32 v[194:195], v[82:83], v[28:29] op_sel:[0,0] op_sel_hi:[1,0]
  v_pk_mul_f32 v[198:199], v[86:87], v[30:31] op_sel:[0,0] op_sel_hi:[1,0]
  v_pk_mul_f32 v[202:203], v[90:91], v[32:33] op_sel:[0,0] op_sel_hi:[1,0]
  v_pk_mul_f32 v[206:207], v[94:95], v[34:35] op_sel:[0,0] op_sel_hi:[1,0]
  v_pk_fma_f32 v[194:195], v[82:83], v[28:29], v[194:195] op_sel:[1,1,0] op_sel_hi:[0,1,1] neg_hi:[1,0,0]
  v_pk_fma_f32 v[198:199], v[86:87], v[30:31], v[198:199] op_sel:[1,1,0] op_sel_hi:[0,1,1] neg_hi:[1,0,0]
  v_pk_fma_f32 v[202:203], v[90:91], v[32:33], v[202:203] op_sel:[1,1,0] op_sel_hi:[0,1,1] neg_hi:[1,0,0]
  v_pk_fma_f32 v[206:207], v[94:95], v[34:35], v[206:207] op_sel:[1,1,0] op_sel_hi:[0,1,1] neg_hi:[1,0,0]
  v_cvt_pk_bf16_f32 v120, v194, v195
  v_cvt_pk_bf16_f32 v121, v198, v199
  v_cvt_pk_bf16_f32 v122, v202, v203
  v_cvt_pk_bf16_f32 v123, v206, v207
  ds_write_b128 v8, v[120:123] offset:2304
  v_pk_add_f32 v[96:97], v[96:97], v[208:209] op_sel:[0,1] op_sel_hi:[1,0] neg_hi:[0,1]
  v_pk_add_f32 v[100:101], v[100:101], v[212:213] op_sel:[0,1] op_sel_hi:[1,0] neg_hi:[0,1]
  v_pk_add_f32 v[104:105], v[104:105], v[216:217] op_sel:[0,1] op_sel_hi:[1,0] neg_hi:[0,1]
  v_pk_add_f32 v[108:109], v[108:109], v[220:221] op_sel:[0,1] op_sel_hi:[1,0] neg_hi:[0,1]
  v_pk_mul_f32 v[208:209], v[96:97], v[36:37] op_sel:[0,0] op_sel_hi:[1,0]
  v_pk_mul_f32 v[212:213], v[100:101], v[38:39] op_sel:[0,0] op_sel_hi:[1,0]
  v_pk_mul_f32 v[216:217], v[104:105], v[40:41] op_sel:[0,0] op_sel_hi:[1,0]
  v_pk_mul_f32 v[220:221], v[108:109], v[42:43] op_sel:[0,0] op_sel_hi:[1,0]
  v_pk_fma_f32 v[208:209], v[96:97], v[36:37], v[208:209] op_sel:[1,1,0] op_sel_hi:[0,1,1] neg_hi:[1,0,0]
  v_pk_fma_f32 v[212:213], v[100:101], v[38:39], v[212:213] op_sel:[1,1,0] op_sel_hi:[0,1,1] neg_hi:[1,0,0]
  v_pk_fma_f32 v[216:217], v[104:105], v[40:41], v[216:217] op_sel:[1,1,0] op_sel_hi:[0,1,1] neg_hi:[1,0,0]
  v_pk_fma_f32 v[220:221], v[108:109], v[42:43], v[220:221] op_sel:[1,1,0] op_sel_hi:[0,1,1] neg_hi:[1,0,0]
  v_cvt_pk_bf16_f32 v116, v208, v209
  v_cvt_pk_bf16_f32 v117, v212, v213
  v_cvt_pk_bf16_f32 v118, v216, v217
  v_cvt_pk_bf16_f32 v119, v220, v221
  ds_write_b128 v8, v[116:119] offset:16
  v_pk_add_f32 v[98:99], v[98:99], v[210:211] op_sel:[0,1] op_sel_hi:[1,0] neg_hi:[0,1]
  v_pk_add_f32 v[102:103], v[102:103], v[214:215] op_sel:[0,1] op_sel_hi:[1,0] neg_hi:[0,1]
  v_pk_add_f32 v[106:107], v[106:107], v[218:219] op_sel:[0,1] op_sel_hi:[1,0] neg_hi:[0,1]
  v_pk_add_f32 v[110:111], v[110:111], v[222:223] op_sel:[0,1] op_sel_hi:[1,0] neg_hi:[0,1]
  v_pk_mul_f32 v[210:211], v[98:99], v[36:37] op_sel:[0,0] op_sel_hi:[1,0]
  v_pk_mul_f32 v[214:215], v[102:103], v[38:39] op_sel:[0,0] op_sel_hi:[1,0]
  v_pk_mul_f32 v[218:219], v[106:107], v[40:41] op_sel:[0,0] op_sel_hi:[1,0]
  v_pk_mul_f32 v[222:223], v[110:111], v[42:43] op_sel:[0,0] op_sel_hi:[1,0]
  v_pk_fma_f32 v[210:211], v[98:99], v[36:37], v[210:211] op_sel:[1,1,0] op_sel_hi:[0,1,1] neg_hi:[1,0,0]
  v_pk_fma_f32 v[214:215], v[102:103], v[38:39], v[214:215] op_sel:[1,1,0] op_sel_hi:[0,1,1] neg_hi:[1,0,0]
  v_pk_fma_f32 v[218:219], v[106:107], v[40:41], v[218:219] op_sel:[1,1,0] op_sel_hi:[0,1,1] neg_hi:[1,0,0]
  v_pk_fma_f32 v[222:223], v[110:111], v[42:43], v[222:223] op_sel:[1,1,0] op_sel_hi:[0,1,1] neg_hi:[1,0,0]
  v_cvt_pk_bf16_f32 v124, v210, v211
  v_cvt_pk_bf16_f32 v125, v214, v215
  v_cvt_pk_bf16_f32 v126, v218, v219
  v_cvt_pk_bf16_f32 v127, v222, v223
  ds_write_b128 v8, v[124:127] offset:2320
  s_waitcnt lgkmcnt(0)
  s_barrier
  ds_read_b128 v[80:83], v9 offset:0
  ds_read_b128 v[84:87], v9 offset:64
  ds_read_b128 v[88:91], v9 offset:2304
  ds_read_b128 v[92:95], v9 offset:2368
  s_waitcnt lgkmcnt(3)
  v_mfma_f32_16x16x32_bf16 v[96:99], v[80:83], v[44:47], 0
  v_mfma_f32_16x16x32_bf16 v[100:103], v[80:83], v[52:55], 0
  s_waitcnt lgkmcnt(2)
  v_mfma_f32_16x16x32_bf16 v[96:99], v[84:87], v[48:51], v[96:99]
  v_mfma_f32_16x16x32_bf16 v[100:103], v[84:87], v[56:59], v[100:103]
  s_waitcnt lgkmcnt(1)
  v_mfma_f32_16x16x32_bf16 v[104:107], v[88:91], v[44:47], 0
  v_mfma_f32_16x16x32_bf16 v[108:111], v[88:91], v[52:55], 0
  s_waitcnt lgkmcnt(0)
  v_mfma_f32_16x16x32_bf16 v[104:107], v[92:95], v[48:51], v[104:107]
  v_mfma_f32_16x16x32_bf16 v[108:111], v[92:95], v[56:59], v[108:111]
  s_waitcnt vmcnt(11)
  v_pk_fma_f32 v[96:97], v[96:97], v[168:169], v[224:225]
  v_pk_fma_f32 v[98:99], v[98:99], v[170:171], v[226:227]
  s_waitcnt vmcnt(10)
  v_pk_fma_f32 v[100:101], v[100:101], v[172:173], v[228:229]
  v_pk_fma_f32 v[102:103], v[102:103], v[174:175], v[230:231]
  v_pk_add_f32 v[64:65], v[96:97], v[98:99]
  v_pk_mul_f32 v[66:67], v[96:97], v[96:97]
  v_pk_add_f32 v[64:65], v[64:65], v[100:101]
  v_pk_fma_f32 v[66:67], v[98:99], v[98:99], v[66:67]
  v_pk_add_f32 v[64:65], v[64:65], v[102:103]
  v_pk_fma_f32 v[66:67], v[100:101], v[100:101], v[66:67]
  v_add_f32 v72, v64, v65
  v_pk_fma_f32 v[66:67], v[102:103], v[102:103], v[66:67]
  v_add_f32 v73, v66, v67
  v_pk_fma_f32 v[104:105], v[104:105], v[168:169], v[232:233]
  v_pk_fma_f32 v[106:107], v[106:107], v[170:171], v[234:235]
  v_pk_fma_f32 v[108:109], v[108:109], v[172:173], v[236:237]
  v_pk_fma_f32 v[110:111], v[110:111], v[174:175], v[238:239]
  v_pk_add_f32 v[68:69], v[104:105], v[106:107]
  v_pk_mul_f32 v[70:71], v[104:105], v[104:105]
  v_pk_add_f32 v[68:69], v[68:69], v[108:109]
  v_pk_fma_f32 v[70:71], v[106:107], v[106:107], v[70:71]
  v_pk_add_f32 v[68:69], v[68:69], v[110:111]
  v_pk_fma_f32 v[70:71], v[108:109], v[108:109], v[70:71]
  v_add_f32 v74, v68, v69
  v_pk_fma_f32 v[70:71], v[110:111], v[110:111], v[70:71]
  v_add_f32 v75, v70, v71
  v_permlane16_swap_b32 v72, v73
  s_nop 0
  v_permlane16_swap_b32 v74, v75
  v_add_f32 v72, v72, v73
  v_add_f32 v74, v74, v75
  v_cvt_pk_bf16_f32 v168, v96, v97
  v_cvt_pk_bf16_f32 v169, v98, v99
  v_permlane32_swap_b32 v72, v74
  v_add_f32 v72, v72, v74
  v_cvt_pk_bf16_f32 v170, v100, v101
  v_cvt_pk_bf16_f32 v171, v102, v103
  v_add_f32 v72, v72, v72 row_ror:8
  v_mov_b32 v76, 0x3b000000
  v_mov_b32 v77, 0x3727c5ac
  v_add_f32 v72, v72, v72 row_ror:4
  v_cvt_pk_bf16_f32 v172, v104, v105
  v_cvt_pk_bf16_f32 v173, v106, v107
  v_add_f32 v72, v72, v72 row_ror:2
  v_cvt_pk_bf16_f32 v174, v108, v109
  v_cvt_pk_bf16_f32 v175, v110, v111
  v_add_f32 v72, v72, v72 row_ror:1
  v_mul_f32 v72, v72, v76
  s_nop 0
  v_readlane_b32 s40, v72, 0
  v_readlane_b32 s41, v72, 16
  v_readlane_b32 s42, v72, 32
  v_readlane_b32 s43, v72, 48
  v_mov_b32 v64, s40
  v_mov_b32 v66, s42
  v_fma_f32 v65, -v64, v64, s41
  v_fma_f32 v67, -v66, v66, s43
  v_max_f32 v65, 0, v65
  v_max_f32 v67, 0, v67
  v_add_f32 v65, v65, v77
  v_add_f32 v67, v67, v77
  v_rsq_f32 v65, v65
  v_rsq_f32 v67, v67
  v_mul_f32 v64, -v64, v65
  v_mul_f32 v66, -v66, v67
  v_pk_fma_f32 v[96:97], v[96:97], v[64:65], v[64:65] op_sel:[0,1,0] op_sel_hi:[1,1,0]
  v_pk_fma_f32 v[98:99], v[98:99], v[64:65], v[64:65] op_sel:[0,1,0] op_sel_hi:[1,1,0]
  s_waitcnt vmcnt(7)
  v_pk_fma_f32 v[96:97], v[96:97], v[176:177], v[184:185]
  v_pk_fma_f32 v[98:99], v[98:99], v[178:179], v[186:187]
  v_cvt_pk_bf16_f32 v120, v96, v97
  v_cvt_pk_bf16_f32 v121, v98, v99
  ds_write_b64 v10, v[120:121] offset:0
  v_pk_fma_f32 v[100:101], v[100:101], v[64:65], v[64:65] op_sel:[0,1,0] op_sel_hi:[1,1,0]
  v_pk_fma_f32 v[102:103], v[102:103], v[64:65], v[64:65] op_sel:[0,1,0] op_sel_hi:[1,1,0]
  s_waitcnt vmcnt(6)
  v_pk_fma_f32 v[100:101], v[100:101], v[180:181], v[188:189]
  v_pk_fma_f32 v[102:103], v[102:103], v[182:183], v[190:191]
  v_cvt_pk_bf16_f32 v122, v100, v101
  v_cvt_pk_bf16_f32 v123, v102, v103
  ds_write_b64 v10, v[122:123] offset:512
  v_pk_fma_f32 v[104:105], v[104:105], v[66:67], v[66:67] op_sel:[0,1,0] op_sel_hi:[1,1,0]
  v_pk_fma_f32 v[106:107], v[106:107], v[66:67], v[66:67] op_sel:[0,1,0] op_sel_hi:[1,1,0]
  v_pk_fma_f32 v[104:105], v[104:105], v[176:177], v[184:185]
  v_pk_fma_f32 v[106:107], v[106:107], v[178:179], v[186:187]
  v_cvt_pk_bf16_f32 v124, v104, v105
  v_cvt_pk_bf16_f32 v125, v106, v107
  ds_write_b64 v10, v[124:125] offset:1088
  v_pk_fma_f32 v[108:109], v[108:109], v[66:67], v[66:67] op_sel:[0,1,0] op_sel_hi:[1,1,0]
  v_pk_fma_f32 v[110:111], v[110:111], v[66:67], v[66:67] op_sel:[0,1,0] op_sel_hi:[1,1,0]
  v_pk_fma_f32 v[108:109], v[108:109], v[180:181], v[188:189]
  v_pk_fma_f32 v[110:111], v[110:111], v[182:183], v[190:191]
  v_cvt_pk_bf16_f32 v126, v108, v109
  v_cvt_pk_bf16_f32 v127, v110, v111
  ds_write_b64 v10, v[126:127] offset:1600
  s_waitcnt lgkmcnt(0)
  s_barrier
  ds_read_b128 v[64:67], v13
  ds_read_b128 v[68:71], v13 offset:512
  s_waitcnt lgkmcnt(1)
  buffer_store_dwordx4 v[64:67], v11, s[32:35], s54 offen sc1
  s_waitcnt lgkmcnt(0)
  buffer_store_dwordx4 v[68:71], v11, s[32:35], s55 offen sc1
  v_mov_b32 v176, v4
  s_mov_b32 s80, s52
  s_mov_b32 s81, s53
  s_waitcnt vmcnt(0) lgkmcnt(0)
  s_barrier
  s_cmp_lg_u32 s3, 0
  s_cbranch_scc1 .fs_21
  v_mov_b32 v250, 0
  v_mov_b32 v251, s64
  s_mov_b64 exec, 1
  buffer_store_dword v251, v250, s[32:35], s62 offen sc1
  s_mov_b64 exec, -1
.fs_21:
  s_add_u32 m0, s67, 98560
  s_add_u32 s75, s66, 704512
  buffer_load_dwordx4 v240, s[8:11], s75 offen  lds
  s_add_u32 m0, s67, 99584
  s_nop 0
  buffer_load_dwordx4 v241, s[8:11], s75 offen  lds
  s_add_u32 m0, s67, 100608
  s_nop 0
  buffer_load_dwordx4 v242, s[8:11], s75 offen  lds
  s_add_u32 m0, s67, 110880
  s_nop 0
  buffer_load_dwordx4 v240, s[12:15], s75 offen  lds
  s_add_u32 m0, s67, 111904
  s_nop 0
  buffer_load_dwordx4 v241, s[12:15], s75 offen  lds
  s_add_u32 m0, s67, 112928
  s_nop 0
  buffer_load_dwordx4 v242, s[12:15], s75 offen  lds
  s_add_u32 m0, s67, 123200
  s_add_u32 s75, s66, 880640
  buffer_load_dwordx4 v240, s[8:11], s75 offen  lds
  s_add_u32 m0, s67, 124224
  s_nop 0
  buffer_load_dwordx4 v241, s[8:11], s75 offen  lds
  s_add_u32 m0, s67, 125248
  s_nop 0
  buffer_load_dwordx4 v242, s[8:11], s75 offen  lds
  s_add_u32 m0, s67, 135520
  s_nop 0
  buffer_load_dwordx4 v240, s[12:15], s75 offen  lds
  s_add_u32 m0, s67, 136544
  s_nop 0
  buffer_load_dwordx4 v241, s[12:15], s75 offen  lds
  s_add_u32 m0, s67, 137568
  s_nop 0
  buffer_load_dwordx4 v242, s[12:15], s75 offen  lds
  s_and_b32 s36, s2, 7
  s_lshl_b32 s36, s36, 2
  s_bfe_u32 s38, s2, 0x20003
  s_add_u32 s36, s36, s38
  s_lshr_b32 s37, s2, 5
  s_lshr_b32 s38, s3, 1
  s_and_b32 s39, s3, 1
  v_lshrrev_b32 v244, 3, v1
  v_lshlrev_b32 v243, 10, v244
  v_and_b32 v245, 7, v1
  v_lshlrev_b32 v244, 1, v244
  v_and_b32 v244, 4, v244
  v_xor_b32 v245, v245, v244
  v_lshl_add_u32 v243, v245, 4, v243
  s_mul_i32 s68, s38, 704512
  s_lshl_b32 s41, s37, 7
  s_add_u32 s68, s68, s41
  s_lshl_b32 s41, s39, 13
  s_add_u32 s68, s68, s41
  s_lshl_b32 s69, s3, 10
  s_mul_i32 s41, s37, 10
  s_lshr_b32 s41, s41, 3
  s_lshl_b32 s41, s41, 16
  s_add_u32 s82, s68, s41
  s_add_u32 s83, s68, 655360
  s_and_b32 s38, s2, 1
  s_lshl_b32 s38, s38, 3
  s_lshr_b32 s39, s2, 5
  s_add_u32 s38, s38, s39
  s_mov_b32 s37, s38
  s_bfe_u32 s36, s2, 0x20001
  s_lshl_b32 s36, s36, 2
  s_bfe_u32 s39, s2, 0x20003
  s_add_u32 s36, s36, s39
  s_lshl_b32 s45, s36, 2
  s_add_u32 s45, s45, s3
  s_lshl_b32 s46, s45, 15
  s_add_u32 s46, s46, 3145728
  v_lshlrev_b32 v4, 4, v1
  v_bfe_u32 v5, v1, 1, 1
  v_mul_u32_u24 v5, 12320, v5
  v_bfe_u32 v6, v1, 2, 2
  v_bfe_u32 v7, v1, 5, 1
  v_lshl_add_u32 v6, v7, 3, v6
  v_mul_u32_u24 v6, 192, v6
  v_add_u32 v5, v5, v6
  v_bfe_u32 v6, v1, 4, 1
  v_lshl_add_u32 v5, v6, 4, v5
  v_and_b32 v6, 1, v1
  v_lshl_add_u32 v5, v6, 3, v5
  v_add_u32 v6, 49280, v5
  v_add_u32 v7, 98560, v5
  s_mul_i32 s47, s45, 88064
  s_mul_i32 s48, s37, 6144
  s_add_u32 s47, s47, s48
  s_add_u32 s47, s47, 8388608
  s_add_u32 s48, s47, 2048
  s_add_u32 s51, s47, 4096
  s_cmp_eq_u32 s37, 14
  s_cselect_b32 s48, 16777216, s48
  s_cselect_b32 s51, 16777216, s51
  s_lshl_b32 s49, s2, 2
  s_add_u32 s49, s49, s3
  s_mul_i32 s49, s49, 11
  v_min_u32 v246, 10, v1
  v_add_u32 v246, s49, v246
  v_lshlrev_b32 v246, 7, v246
  v_mov_b32 v14, 0xbfb8aa3b
  v_mov_b32 v15, 0xbfb8aa3b
  s_lshl_b32 s61, s36, 4
  s_add_u32 s61, s61, s37
  s_lshl_b32 s61, s61, 7
  s_add_u32 s61, s61, 14811136
  s_lshl_b32 s62, s36, 11
  s_add_u32 s62, s62, 14745600
  s_cmp_eq_u32 s37, 15
  s_cbranch_scc1 .k3idle_22
  s_cmp_eq_u32 s3, 0
  s_cbranch_scc1 .p0_25
  s_branch .pj_26
.p0_25:
  s_mov_b32 s65, 0
  v_lshlrev_b32 v250, 7, v2
  s_mov_b64 exec, 0xffff
.pl_24:
  buffer_load_dword v252, v250, s[32:35], s62 offen sc1
  s_add_u32 s65, s65, 1
  s_waitcnt vmcnt(0)
  v_cmp_ne_u32 vcc, s64, v252
  s_cmp_ge_u32 s65, 400000
  s_cbranch_scc1 .pk_23
  s_and_b64 exec, exec, vcc
  s_cbranch_execz .pk_23
  s_branch .pl_24
.pk_23:
  s_mov_b64 exec, -1
.pj_26:
  s_barrier
.Lk3code:
  s_cmp_eq_u32 s37, 14
  s_cbranch_scc1 .k3short_28
  buffer_load_dwordx4 a[0:3], v4, s[32:35], s46 offen offset:0 sc1
  buffer_load_dwordx4 a[4:7], v4, s[32:35], s46 offen offset:1024 sc1
  buffer_load_dwordx4 a[8:11], v4, s[32:35], s46 offen offset:2048 sc1
  buffer_load_dwordx4 a[12:15], v4, s[32:35], s46 offen offset:3072 sc1
  s_add_u32 s46, s46, 4096
  buffer_load_dwordx4 a[16:19], v4, s[32:35], s46 offen offset:0 sc1
  buffer_load_dwordx4 a[20:23], v4, s[32:35], s46 offen offset:1024 sc1
  buffer_load_dwordx4 a[24:27], v4, s[32:35], s46 offen offset:2048 sc1
  buffer_load_dwordx4 a[28:31], v4, s[32:35], s46 offen offset:3072 sc1
  s_add_u32 s46, s46, 4096
  buffer_load_dwordx4 a[32:35], v4, s[32:35], s46 offen offset:0 sc1
  ds_read_b64_tr_b16 v[112:113], v5 offset:0
  ds_read_b64_tr_b16 v[114:115], v5 offset:768
  ds_read_b64_tr_b16 v[116:117], v5 offset:32
  ds_read_b64_tr_b16 v[118:119], v5 offset:800
  ds_read_b64_tr_b16 v[120:121], v5 offset:64
  ds_read_b64_tr_b16 v[122:123], v5 offset:832
  ds_read_b64_tr_b16 v[124:125], v5 offset:96
  ds_read_b64_tr_b16 v[126:127], v5 offset:864
  ds_read_b64_tr_b16 v[128:129], v5 offset:128
  ds_read_b64_tr_b16 v[130:131], v5 offset:896
  ds_read_b64_tr_b16 v[132:133], v5 offset:160
  ds_read_b64_tr_b16 v[134:135], v5 offset:928
  s_waitcnt lgkmcnt(8)
  s_waitcnt vmcnt(8)
  v_mfma_f32_32x32x16_bf16 v[16:31], v[112:115], a[0:3], 0
  buffer_load_dwordx4 a[36:39], v4, s[32:35], s46 offen offset:1024 sc1
  ds_read_b64_tr_b16 v[136:137], v5 offset:3072
  ds_read_b64_tr_b16 v[138:139], v5 offset:3840
  v_mfma_f32_32x32x16_bf16 v[32:47], v[116:119], a[0:3], 0
  ds_read_b64_tr_b16 v[140:141], v5 offset:3104
  ds_read_b64_tr_b16 v[142:143], v5 offset:3872
  s_waitcnt lgkmcnt(8)
  v_mfma_f32_32x32x16_bf16 v[48:63], v[120:123], a[0:3], 0
  buffer_load_dwordx4 a[40:43], v4, s[32:35], s46 offen offset:2048 sc1
  ds_read_b64_tr_b16 v[112:113], v5 offset:3136
  ds_read_b64_tr_b16 v[114:115], v5 offset:3904
  v_mfma_f32_32x32x16_bf16 v[64:79], v[124:127], a[0:3], 0
  ds_read_b64_tr_b16 v[116:117], v5 offset:3168
  ds_read_b64_tr_b16 v[118:119], v5 offset:3936
  s_waitcnt lgkmcnt(8)
  v_mfma_f32_32x32x16_bf16 v[80:95], v[128:131], a[0:3], 0
  buffer_load_dwordx4 a[44:47], v4, s[32:35], s46 offen offset:3072 sc1
  ds_read_b64_tr_b16 v[120:121], v5 offset:3200
  ds_read_b64_tr_b16 v[122:123], v5 offset:3968
  v_mfma_f32_32x32x16_bf16 v[96:111], v[132:135], a[0:3], 0
  ds_read_b64_tr_b16 v[124:125], v5 offset:3232
  ds_read_b64_tr_b16 v[126:127], v5 offset:4000
  s_waitcnt lgkmcnt(8)
  s_waitcnt vmcnt(10)
  v_mfma_f32_32x32x16_bf16 v[16:31], v[136:139], a[4:7], v[16:31]
  s_add_u32 s46, s46, 4096
  buffer_load_dwordx4 a[48:51], v4, s[32:35], s46 offen offset:0 sc1
  ds_read_b64_tr_b16 v[128:129], v5 offset:6144
  ds_read_b64_tr_b16 v[130:131], v5 offset:6912
  v_mfma_f32_32x32x16_bf16 v[32:47], v[140:143], a[4:7], v[32:47]
  ds_read_b64_tr_b16 v[132:133], v5 offset:6176
  ds_read_b64_tr_b16 v[134:135], v5 offset:6944
  s_waitcnt lgkmcnt(8)
  v_mfma_f32_32x32x16_bf16 v[48:63], v[112:115], a[4:7], v[48:63]
  buffer_load_dwordx4 a[52:55], v4, s[32:35], s46 offen offset:1024 sc1
  ds_read_b64_tr_b16 v[136:137], v5 offset:6208
  ds_read_b64_tr_b16 v[138:139], v5 offset:6976
  v_mfma_f32_32x32x16_bf16 v[64:79], v[116:119], a[4:7], v[64:79]
  ds_read_b64_tr_b16 v[140:141], v5 offset:6240
  ds_read_b64_tr_b16 v[142:143], v5 offset:7008
  s_waitcnt lgkmcnt(8)
  v_mfma_f32_32x32x16_bf16 v[80:95], v[120:123], a[4:7], v[80:95]
  buffer_load_dwordx4 a[56:59], v4, s[32:35], s46 offen offset:2048 sc1
  ds_read_b64_tr_b16 v[112:113], v5 offset:6272
  ds_read_b64_tr_b16 v[114:115], v5 offset:7040
  v_mfma_f32_32x32x16_bf16 v[96:111], v[124:127], a[4:7], v[96:111]
  ds_read_b64_tr_b16 v[116:117], v5 offset:6304
  ds_read_b64_tr_b16 v[118:119], v5 offset:7072
  s_waitcnt lgkmcnt(8)
  s_waitcnt vmcnt(12)
  v_mfma_f32_32x32x16_bf16 v[16:31], v[128:131], a[8:11], v[16:31]
  buffer_load_dwordx4 a[60:63], v4, s[32:35], s46 offen offset:3072 sc1
  ds_read_b64_tr_b16 v[120:121], v5 offset:9216
  ds_read_b64_tr_b16 v[122:123], v5 offset:9984
  v_mfma_f32_32x32x16_bf16 v[32:47], v[132:135], a[8:11], v[32:47]
  ds_read_b64_tr_b16 v[124:125], v5 offset:9248
  ds_read_b64_tr_b16 v[126:127], v5 offset:10016
  s_waitcnt lgkmcnt(8)
  v_mfma_f32_32x32x16_bf16 v[48:63], v[136:139], a[8:11], v[48:63]
  s_add_u32 s46, s46, 4096
  buffer_load_dwordx4 a[64:67], v4, s[32:35], s46 offen offset:0 sc1
  ds_read_b64_tr_b16 v[128:129], v5 offset:9280
  ds_read_b64_tr_b16 v[130:131], v5 offset:10048
  v_mfma_f32_32x32x16_bf16 v[64:79], v[140:143], a[8:11], v[64:79]
  ds_read_b64_tr_b16 v[132:133], v5 offset:9312
  ds_read_b64_tr_b16 v[134:135], v5 offset:10080
  s_waitcnt lgkmcnt(8)
  v_mfma_f32_32x32x16_bf16 v[80:95], v[112:115], a[8:11], v[80:95]
  buffer_load_dwordx4 a[68:71], v4, s[32:35], s46 offen offset:1024 sc1
  ds_read_b64_tr_b16 v[136:137], v5 offset:9344
  ds_read_b64_tr_b16 v[138:139], v5 offset:10112
  v_mfma_f32_32x32x16_bf16 v[96:111], v[116:119], a[8:11], v[96:111]
  ds_read_b64_tr_b16 v[140:141], v5 offset:9376
  ds_read_b64_tr_b16 v[142:143], v5 offset:10144
  s_waitcnt lgkmcnt(8)
  s_waitcnt vmcnt(14)
  v_mfma_f32_32x32x16_bf16 v[16:31], v[120:123], a[12:15], v[16:31]
  buffer_load_dwordx4 a[72:75], v4, s[32:35], s46 offen offset:2048 sc1
  ds_read_b64_tr_b16 v[112:113], v5 offset:24640
  ds_read_b64_tr_b16 v[114:115], v5 offset:25408
  v_mfma_f32_32x32x16_bf16 v[32:47], v[124:127], a[12:15], v[32:47]
  ds_read_b64_tr_b16 v[116:117], v5 offset:24672
  ds_read_b64_tr_b16 v[118:119], v5 offset:25440
  s_waitcnt lgkmcnt(8)
  v_mfma_f32_32x32x16_bf16 v[48:63], v[128:131], a[12:15], v[48:63]
  buffer_load_dwordx4 a[76:79], v4, s[32:35], s46 offen offset:3072 sc1
  ds_read_b64_tr_b16 v[120:121], v5 offset:24704
  ds_read_b64_tr_b16 v[122:123], v5 offset:25472
  v_mfma_f32_32x32x16_bf16 v[64:79], v[132:135], a[12:15], v[64:79]
  ds_read_b64_tr_b16 v[124:125], v5 offset:24736
  ds_read_b64_tr_b16 v[126:127], v5 offset:25504
  s_waitcnt lgkmcnt(8)
  v_mfma_f32_32x32x16_bf16 v[80:95], v[136:139], a[12:15], v[80:95]
  s_add_u32 s46, s46, 4096
  buffer_load_dwordx4 a[80:83], v4, s[32:35], s46 offen offset:0 sc1
  ds_read_b64_tr_b16 v[128:129], v5 offset:24768
  ds_read_b64_tr_b16 v[130:131], v5 offset:25536
  v_mfma_f32_32x32x16_bf16 v[96:111], v[140:143], a[12:15], v[96:111]
  ds_read_b64_tr_b16 v[132:133], v5 offset:24800
  ds_read_b64_tr_b16 v[134:135], v5 offset:25568
  s_waitcnt lgkmcnt(8)
  s_waitcnt vmcnt(16)
  v_mfma_f32_32x32x16_bf16 v[16:31], v[112:115], a[16:19], v[16:31]
  buffer_load_dwordx4 a[84:87], v4, s[32:35], s46 offen offset:1024 sc1
  ds_read_b64_tr_b16 v[136:137], v5 offset:27712
  ds_read_b64_tr_b16 v[138:139], v5 offset:28480
  v_mfma_f32_32x32x16_bf16 v[32:47], v[116:119], a[16:19], v[32:47]
  ds_read_b64_tr_b16 v[140:141], v5 offset:27744
  ds_read_b64_tr_b16 v[142:143], v5 offset:28512
  s_waitcnt lgkmcnt(8)
  v_mfma_f32_32x32x16_bf16 v[48:63], v[120:123], a[16:19], v[48:63]
  buffer_load_dwordx4 a[88:91], v4, s[32:35], s46 offen offset:2048 sc1
  ds_read_b64_tr_b16 v[112:113], v5 offset:27776
  ds_read_b64_tr_b16 v[114:115], v5 offset:28544
  v_mfma_f32_32x32x16_bf16 v[64:79], v[124:127], a[16:19], v[64:79]
  ds_read_b64_tr_b16 v[116:117], v5 offset:27808
  ds_read_b64_tr_b16 v[118:119], v5 offset:28576
  s_waitcnt lgkmcnt(8)
  v_mfma_f32_32x32x16_bf16 v[80:95], v[128:131], a[16:19], v[80:95]
  buffer_load_dwordx4 a[92:95], v4, s[32:35], s46 offen offset:3072 sc1
  ds_read_b64_tr_b16 v[120:121], v5 offset:27840
  ds_read_b64_tr_b16 v[122:123], v5 offset:28608
  v_mfma_f32_32x32x16_bf16 v[96:111], v[132:135], a[16:19], v[96:111]
  ds_read_b64_tr_b16 v[124:125], v5 offset:27872
  ds_read_b64_tr_b16 v[126:127], v5 offset:28640
  s_waitcnt lgkmcnt(8)
  s_waitcnt vmcnt(18)
  v_mfma_f32_32x32x16_bf16 v[16:31], v[136:139], a[20:23], v[16:31]
  s_add_u32 s46, s46, 4096
  buffer_load_dwordx4 a[96:99], v4, s[32:35], s46 offen offset:0 sc1
  ds_read_b64_tr_b16 v[128:129], v5 offset:30784
  ds_read_b64_tr_b16 v[130:131], v5 offset:31552
  v_mfma_f32_32x32x16_bf16 v[32:47], v[140:143], a[20:23], v[32:47]
  ds_read_b64_tr_b16 v[132:133], v5 offset:30816
  ds_read_b64_tr_b16 v[134:135], v5 offset:31584
  s_waitcnt lgkmcnt(8)
  v_mfma_f32_32x32x16_bf16 v[48:63], v[112:115], a[20:23], v[48:63]
  buffer_load_dwordx4 a[100:103], v4, s[32:35], s46 offen offset:1024 sc1
  ds_read_b64_tr_b16 v[136:137], v5 offset:30848
  ds_read_b64_tr_b16 v[138:139], v5 offset:31616
  v_mfma_f32_32x32x16_bf16 v[64:79], v[116:119], a[20:23], v[64:79]
  ds_read_b64_tr_b16 v[140:141], v5 offset:30880
  ds_read_b64_tr_b16 v[142:143], v5 offset:31648
  s_waitcnt lgkmcnt(8)
  v_mfma_f32_32x32x16_bf16 v[80:95], v[120:123], a[20:23], v[80:95]
  buffer_load_dwordx4 a[104:107], v4, s[32:35], s46 offen offset:2048 sc1
  ds_read_b64_tr_b16 v[112:113], v5 offset:30912
  ds_read_b64_tr_b16 v[114:115], v5 offset:31680
  v_mfma_f32_32x32x16_bf16 v[96:111], v[124:127], a[20:23], v[96:111]
  ds_read_b64_tr_b16 v[116:117], v5 offset:30944
  ds_read_b64_tr_b16 v[118:119], v5 offset:31712
  s_waitcnt lgkmcnt(8)
  s_waitcnt vmcnt(20)
  v_mfma_f32_32x32x16_bf16 v[16:31], v[128:131], a[24:27], v[16:31]
  buffer_load_dwordx4 a[108:111], v4, s[32:35], s46 offen offset:3072 sc1
  ds_read_b64_tr_b16 v[120:121], v5 offset:33856
  ds_read_b64_tr_b16 v[122:123], v5 offset:34624
  v_mfma_f32_32x32x16_bf16 v[32:47], v[132:135], a[24:27], v[32:47]
  ds_read_b64_tr_b16 v[124:125], v5 offset:33888
  ds_read_b64_tr_b16 v[126:127], v5 offset:34656
  s_waitcnt lgkmcnt(8)
  v_mfma_f32_32x32x16_bf16 v[48:63], v[136:139], a[24:27], v[48:63]
  s_add_u32 s46, s46, 4096
  buffer_load_dwordx4 a[112:115], v4, s[32:35], s46 offen offset:0 sc1
  ds_read_b64_tr_b16 v[128:129], v5 offset:33920
  ds_read_b64_tr_b16 v[130:131], v5 offset:34688
  v_mfma_f32_32x32x16_bf16 v[64:79], v[140:143], a[24:27], v[64:79]
  ds_read_b64_tr_b16 v[132:133], v5 offset:33952
  ds_read_b64_tr_b16 v[134:135], v5 offset:34720
  s_waitcnt lgkmcnt(8)
  v_mfma_f32_32x32x16_bf16 v[80:95], v[112:115], a[24:27], v[80:95]
  buffer_load_dwordx4 a[116:119], v4, s[32:35], s46 offen offset:1024 sc1
  ds_read_b64_tr_b16 v[136:137], v5 offset:33984
  ds_read_b64_tr_b16 v[138:139], v5 offset:34752
  v_mfma_f32_32x32x16_bf16 v[96:111], v[116:119], a[24:27], v[96:111]
  ds_read_b64_tr_b16 v[140:141], v5 offset:34016
  ds_read_b64_tr_b16 v[142:143], v5 offset:34784
  s_waitcnt lgkmcnt(8)
  s_waitcnt vmcnt(22)
  v_mfma_f32_32x32x16_bf16 v[16:31], v[120:123], a[28:31], v[16:31]
  buffer_load_dwordx4 a[120:123], v4, s[32:35], s46 offen offset:2048 sc1
  ds_read_b64_tr_b16 v[112:113], v6 offset:0
  ds_read_b64_tr_b16 v[114:115], v6 offset:768
  v_mfma_f32_32x32x16_bf16 v[32:47], v[124:127], a[28:31], v[32:47]
  ds_read_b64_tr_b16 v[116:117], v6 offset:32
  ds_read_b64_tr_b16 v[118:119], v6 offset:800
  s_waitcnt lgkmcnt(8)
  v_mfma_f32_32x32x16_bf16 v[48:63], v[128:131], a[28:31], v[48:63]
  buffer_load_dwordx4 a[124:127], v4, s[32:35], s46 offen offset:3072 sc1
  ds_read_b64_tr_b16 v[120:121], v6 offset:64
  ds_read_b64_tr_b16 v[122:123], v6 offset:832
  v_mfma_f32_32x32x16_bf16 v[64:79], v[132:135], a[28:31], v[64:79]
  ds_read_b64_tr_b16 v[124:125], v6 offset:96
  ds_read_b64_tr_b16 v[126:127], v6 offset:864
  s_waitcnt lgkmcnt(8)
  v_mfma_f32_32x32x16_bf16 v[80:95], v[136:139], a[28:31], v[80:95]
  ds_read_b64_tr_b16 v[128:129], v6 offset:128
  ds_read_b64_tr_b16 v[130:131], v6 offset:896
  v_mfma_f32_32x32x16_bf16 v[96:111], v[140:143], a[28:31], v[96:111]
  s_barrier
  ds_read_b64_tr_b16 v[132:133], v6 offset:160
  ds_read_b64_tr_b16 v[134:135], v6 offset:928
  s_waitcnt lgkmcnt(8)
  s_waitcnt vmcnt(23)
  v_mfma_f32_32x32x16_bf16 v[16:31], v[112:115], a[32:35], v[16:31]
  s_add_u32 m0, s67, 0
  s_add_u32 s75, s66, 1056768
  buffer_load_dwordx4 v240, s[8:11], s75 offen  lds
  ds_read_b64_tr_b16 v[136:137], v6 offset:3072
  ds_read_b64_tr_b16 v[138:139], v6 offset:3840
  v_mfma_f32_32x32x16_bf16 v[32:47], v[116:119], a[32:35], v[32:47]
  ds_read_b64_tr_b16 v[140:141], v6 offset:3104
  ds_read_b64_tr_b16 v[142:143], v6 offset:3872
  s_waitcnt lgkmcnt(8)
  v_mfma_f32_32x32x16_bf16 v[48:63], v[120:123], a[32:35], v[48:63]
  s_add_u32 m0, s67, 1024
  s_nop 0
  buffer_load_dwordx4 v241, s[8:11], s75 offen  lds
  ds_read_b64_tr_b16 v[112:113], v6 offset:3136
  ds_read_b64_tr_b16 v[114:115], v6 offset:3904
  v_mfma_f32_32x32x16_bf16 v[64:79], v[124:127], a[32:35], v[64:79]
  ds_read_b64_tr_b16 v[116:117], v6 offset:3168
  ds_read_b64_tr_b16 v[118:119], v6 offset:3936
  s_waitcnt lgkmcnt(8)
  v_mfma_f32_32x32x16_bf16 v[80:95], v[128:131], a[32:35], v[80:95]
  s_add_u32 m0, s67, 2048
  s_nop 0
  buffer_load_dwordx4 v242, s[8:11], s75 offen  lds
  ds_read_b64_tr_b16 v[120:121], v6 offset:3200
  ds_read_b64_tr_b16 v[122:123], v6 offset:3968
  v_mfma_f32_32x32x16_bf16 v[96:111], v[132:135], a[32:35], v[96:111]
  ds_read_b64_tr_b16 v[124:125], v6 offset:3232
  ds_read_b64_tr_b16 v[126:127], v6 offset:4000
  s_waitcnt lgkmcnt(8)
  s_waitcnt vmcnt(25)
  v_mfma_f32_32x32x16_bf16 v[16:31], v[136:139], a[36:39], v[16:31]
  s_add_u32 m0, s67, 12320
  s_nop 0
  buffer_load_dwordx4 v240, s[12:15], s75 offen  lds
  ds_read_b64_tr_b16 v[128:129], v6 offset:6144
  ds_read_b64_tr_b16 v[130:131], v6 offset:6912
  v_mfma_f32_32x32x16_bf16 v[32:47], v[140:143], a[36:39], v[32:47]
  ds_read_b64_tr_b16 v[132:133], v6 offset:6176
  ds_read_b64_tr_b16 v[134:135], v6 offset:6944
  s_waitcnt lgkmcnt(8)
  v_mfma_f32_32x32x16_bf16 v[48:63], v[112:115], a[36:39], v[48:63]
  s_add_u32 m0, s67, 13344
  s_nop 0
  buffer_load_dwordx4 v241, s[12:15], s75 offen  lds
  ds_read_b64_tr_b16 v[136:137], v6 offset:6208
  ds_read_b64_tr_b16 v[138:139], v6 offset:6976
  v_mfma_f32_32x32x16_bf16 v[64:79], v[116:119], a[36:39], v[64:79]
  ds_read_b64_tr_b16 v[140:141], v6 offset:6240
  ds_read_b64_tr_b16 v[142:143], v6 offset:7008
  s_waitcnt lgkmcnt(8)
  v_mfma_f32_32x32x16_bf16 v[80:95], v[120:123], a[36:39], v[80:95]
  s_add_u32 m0, s67, 14368
  s_nop 0
  buffer_load_dwordx4 v242, s[12:15], s75 offen  lds
  ds_read_b64_tr_b16 v[112:113], v6 offset:6272
  ds_read_b64_tr_b16 v[114:115], v6 offset:7040
  v_mfma_f32_32x32x16_bf16 v[96:111], v[124:127], a[36:39], v[96:111]
  ds_read_b64_tr_b16 v[116:117], v6 offset:6304
  ds_read_b64_tr_b16 v[118:119], v6 offset:7072
  s_waitcnt lgkmcnt(8)
  s_waitcnt vmcnt(27)
  v_mfma_f32_32x32x16_bf16 v[16:31], v[128:131], a[40:43], v[16:31]
  s_add_u32 m0, s67, 24640
  s_add_u32 s75, s66, 1232896
  buffer_load_dwordx4 v240, s[8:11], s75 offen  lds
  ds_read_b64_tr_b16 v[120:121], v6 offset:9216
  ds_read_b64_tr_b16 v[122:123], v6 offset:9984
  v_mfma_f32_32x32x16_bf16 v[32:47], v[132:135], a[40:43], v[32:47]
  ds_read_b64_tr_b16 v[124:125], v6 offset:9248
  ds_read_b64_tr_b16 v[126:127], v6 offset:10016
  s_waitcnt lgkmcnt(8)
  v_mfma_f32_32x32x16_bf16 v[48:63], v[136:139], a[40:43], v[48:63]
  s_add_u32 m0, s67, 25664
  s_nop 0
  buffer_load_dwordx4 v241, s[8:11], s75 offen  lds
  ds_read_b64_tr_b16 v[128:129], v6 offset:9280
  ds_read_b64_tr_b16 v[130:131], v6 offset:10048
  v_mfma_f32_32x32x16_bf16 v[64:79], v[140:143], a[40:43], v[64:79]
  ds_read_b64_tr_b16 v[132:133], v6 offset:9312
  ds_read_b64_tr_b16 v[134:135], v6 offset:10080
  s_waitcnt lgkmcnt(8)
  v_mfma_f32_32x32x16_bf16 v[80:95], v[112:115], a[40:43], v[80:95]
  s_add_u32 m0, s67, 26688
  s_nop 0
  buffer_load_dwordx4 v242, s[8:11], s75 offen  lds
  ds_read_b64_tr_b16 v[136:137], v6 offset:9344
  ds_read_b64_tr_b16 v[138:139], v6 offset:10112
  v_mfma_f32_32x32x16_bf16 v[96:111], v[116:119], a[40:43], v[96:111]
  ds_read_b64_tr_b16 v[140:141], v6 offset:9376
  ds_read_b64_tr_b16 v[142:143], v6 offset:10144
  s_waitcnt lgkmcnt(8)
  s_waitcnt vmcnt(29)
  v_mfma_f32_32x32x16_bf16 v[16:31], v[120:123], a[44:47], v[16:31]
  s_add_u32 m0, s67, 36960
  s_nop 0
  buffer_load_dwordx4 v240, s[12:15], s75 offen  lds
  ds_read_b64_tr_b16 v[112:113], v6 offset:24640
  ds_read_b64_tr_b16 v[114:115], v6 offset:25408
  v_mfma_f32_32x32x16_bf16 v[32:47], v[124:127], a[44:47], v[32:47]
  ds_read_b64_tr_b16 v[116:117], v6 offset:24672
  ds_read_b64_tr_b16 v[118:119], v6 offset:25440
  s_waitcnt lgkmcnt(8)
  v_mfma_f32_32x32x16_bf16 v[48:63], v[128:131], a[44:47], v[48:63]
  s_add_u32 m0, s67, 37984
  s_nop 0
  buffer_load_dwordx4 v241, s[12:15], s75 offen  lds
  ds_read_b64_tr_b16 v[120:121], v6 offset:24704
  ds_read_b64_tr_b16 v[122:123], v6 offset:25472
  v_mfma_f32_32x32x16_bf16 v[64:79], v[132:135], a[44:47], v[64:79]
  ds_read_b64_tr_b16 v[124:125], v6 offset:24736
  ds_read_b64_tr_b16 v[126:127], v6 offset:25504
  s_waitcnt lgkmcnt(8)
  v_mfma_f32_32x32x16_bf16 v[80:95], v[136:139], a[44:47], v[80:95]
  s_add_u32 m0, s67, 39008
  s_nop 0
  buffer_load_dwordx4 v242, s[12:15], s75 offen  lds
  ds_read_b64_tr_b16 v[128:129], v6 offset:24768
  ds_read_b64_tr_b16 v[130:131], v6 offset:25536
  v_mfma_f32_32x32x16_bf16 v[96:111], v[140:143], a[44:47], v[96:111]
  ds_read_b64_tr_b16 v[132:133], v6 offset:24800
  ds_read_b64_tr_b16 v[134:135], v6 offset:25568
  s_waitcnt lgkmcnt(8)
  s_waitcnt vmcnt(31)
  v_mfma_f32_32x32x16_bf16 v[16:31], v[112:115], a[48:51], v[16:31]
  buffer_store_dwordx2 v[168:169], v176, s[32:35], s80 offen offset:0 sc1
  ds_read_b64_tr_b16 v[136:137], v6 offset:27712
  ds_read_b64_tr_b16 v[138:139], v6 offset:28480
  v_mfma_f32_32x32x16_bf16 v[32:47], v[116:119], a[48:51], v[32:47]
  ds_read_b64_tr_b16 v[140:141], v6 offset:27744
  ds_read_b64_tr_b16 v[142:143], v6 offset:28512
  s_waitcnt lgkmcnt(8)
  v_mfma_f32_32x32x16_bf16 v[48:63], v[120:123], a[48:51], v[48:63]
  buffer_store_dwordx2 v[170:171], v176, s[32:35], s80 offen offset:512 sc1
  ds_read_b64_tr_b16 v[112:113], v6 offset:27776
  ds_read_b64_tr_b16 v[114:115], v6 offset:28544
  v_mfma_f32_32x32x16_bf16 v[64:79], v[124:127], a[48:51], v[64:79]
  ds_read_b64_tr_b16 v[116:117], v6 offset:27808
  ds_read_b64_tr_b16 v[118:119], v6 offset:28576
  s_waitcnt lgkmcnt(8)
  v_mfma_f32_32x32x16_bf16 v[80:95], v[128:131], a[48:51], v[80:95]
  buffer_store_dwordx2 v[172:173], v176, s[32:35], s81 offen offset:0 sc1
  ds_read_b64_tr_b16 v[120:121], v6 offset:27840
  ds_read_b64_tr_b16 v[122:123], v6 offset:28608
  v_mfma_f32_32x32x16_bf16 v[96:111], v[132:135], a[48:51], v[96:111]
  ds_read_b64_tr_b16 v[124:125], v6 offset:27872
  ds_read_b64_tr_b16 v[126:127], v6 offset:28640
  s_waitcnt lgkmcnt(8)
  s_waitcnt vmcnt(33)
  v_mfma_f32_32x32x16_bf16 v[16:31], v[136:139], a[52:55], v[16:31]
  buffer_store_dwordx2 v[174:175], v176, s[32:35], s81 offen offset:512 sc1
  ds_read_b64_tr_b16 v[128:129], v6 offset:30784
  ds_read_b64_tr_b16 v[130:131], v6 offset:31552
  v_mfma_f32_32x32x16_bf16 v[32:47], v[140:143], a[52:55], v[32:47]
  ds_read_b64_tr_b16 v[132:133], v6 offset:30816
  ds_read_b64_tr_b16 v[134:135], v6 offset:31584
  s_waitcnt lgkmcnt(8)
  v_mfma_f32_32x32x16_bf16 v[48:63], v[112:115], a[52:55], v[48:63]
  s_add_u32 m0, s69, 151552
  s_add_u32 s70, s68, 0
  buffer_load_dwordx4 v243, s[16:19], s70 offen  lds
  ds_read_b64_tr_b16 v[136:137], v6 offset:30848
  ds_read_b64_tr_b16 v[138:139], v6 offset:31616
  v_mfma_f32_32x32x16_bf16 v[64:79], v[116:119], a[52:55], v[64:79]
  ds_read_b64_tr_b16 v[140:141], v6 offset:30880
  ds_read_b64_tr_b16 v[142:143], v6 offset:31648
  s_waitcnt lgkmcnt(8)
  v_mfma_f32_32x32x16_bf16 v[80:95], v[120:123], a[52:55], v[80:95]
  ds_read_b64_tr_b16 v[112:113], v6 offset:30912
  ds_read_b64_tr_b16 v[114:115], v6 offset:31680
  v_mfma_f32_32x32x16_bf16 v[96:111], v[124:127], a[52:55], v[96:111]
  s_add_u32 m0, s69, 155648
  s_add_u32 s70, s68, 16384
  buffer_load_dwordx4 v243, s[16:19], s70 offen  lds
  ds_read_b64_tr_b16 v[116:117], v6 offset:30944
  ds_read_b64_tr_b16 v[118:119], v6 offset:31712
  s_waitcnt lgkmcnt(8)
  s_waitcnt vmcnt(35)
  v_mfma_f32_32x32x16_bf16 v[16:31], v[128:131], a[56:59], v[16:31]
  ds_read_b64_tr_b16 v[120:121], v6 offset:33856
  ds_read_b64_tr_b16 v[122:123], v6 offset:34624
  v_mfma_f32_32x32x16_bf16 v[32:47], v[132:135], a[56:59], v[32:47]
  ds_read_b64_tr_b16 v[124:125], v6 offset:33888
  ds_read_b64_tr_b16 v[126:127], v6 offset:34656
  s_waitcnt lgkmcnt(8)
  v_mfma_f32_32x32x16_bf16 v[48:63], v[136:139], a[56:59], v[48:63]
  s_add_u32 m0, s69, 159744
  s_add_u32 s70, s68, 32768
  buffer_load_dwordx4 v243, s[16:19], s70 offen  lds
  ds_read_b64_tr_b16 v[128:129], v6 offset:33920
  ds_read_b64_tr_b16 v[130:131], v6 offset:34688
  v_mfma_f32_32x32x16_bf16 v[64:79], v[140:143], a[56:59], v[64:79]
  ds_read_b64_tr_b16 v[132:133], v6 offset:33952
  ds_read_b64_tr_b16 v[134:135], v6 offset:34720
  s_waitcnt lgkmcnt(8)
  v_mfma_f32_32x32x16_bf16 v[80:95], v[112:115], a[56:59], v[80:95]
  ds_read_b64_tr_b16 v[136:137], v6 offset:33984
  ds_read_b64_tr_b16 v[138:139], v6 offset:34752
  v_mfma_f32_32x32x16_bf16 v[96:111], v[116:119], a[56:59], v[96:111]
  ds_read_b64_tr_b16 v[140:141], v6 offset:34016
  ds_read_b64_tr_b16 v[142:143], v6 offset:34784
  s_waitcnt lgkmcnt(8)
  s_waitcnt vmcnt(35)
  v_mfma_f32_32x32x16_bf16 v[16:31], v[120:123], a[60:63], v[16:31]
  ds_read_b64_tr_b16 v[112:113], v7 offset:0
  ds_read_b64_tr_b16 v[114:115], v7 offset:768
  v_mfma_f32_32x32x16_bf16 v[32:47], v[124:127], a[60:63], v[32:47]
  ds_read_b64_tr_b16 v[116:117], v7 offset:32
  ds_read_b64_tr_b16 v[118:119], v7 offset:800
  s_waitcnt lgkmcnt(8)
  v_mfma_f32_32x32x16_bf16 v[48:63], v[128:131], a[60:63], v[48:63]
  ds_read_b64_tr_b16 v[120:121], v7 offset:64
  ds_read_b64_tr_b16 v[122:123], v7 offset:832
  v_mfma_f32_32x32x16_bf16 v[64:79], v[132:135], a[60:63], v[64:79]
  ds_read_b64_tr_b16 v[124:125], v7 offset:96
  ds_read_b64_tr_b16 v[126:127], v7 offset:864
  s_waitcnt lgkmcnt(8)
  v_mfma_f32_32x32x16_bf16 v[80:95], v[136:139], a[60:63], v[80:95]
  ds_read_b64_tr_b16 v[128:129], v7 offset:128
  ds_read_b64_tr_b16 v[130:131], v7 offset:896
  v_mfma_f32_32x32x16_bf16 v[96:111], v[140:143], a[60:63], v[96:111]
  s_barrier
  ds_read_b64_tr_b16 v[132:133], v7 offset:160
  ds_read_b64_tr_b16 v[134:135], v7 offset:928
  s_waitcnt lgkmcnt(8)
  s_waitcnt vmcnt(34)
  v_mfma_f32_32x32x16_bf16 v[16:31], v[112:115], a[64:67], v[16:31]
  s_add_u32 m0, s69, 53248
  s_add_u32 s70, s68, 49152
  buffer_load_dwordx4 v243, s[16:19], s70 offen  lds
  ds_read_b64_tr_b16 v[136:137], v7 offset:3072
  ds_read_b64_tr_b16 v[138:139], v7 offset:3840
  v_mfma_f32_32x32x16_bf16 v[32:47], v[116:119], a[64:67], v[32:47]
  ds_read_b64_tr_b16 v[140:141], v7 offset:3104
  ds_read_b64_tr_b16 v[142:143], v7 offset:3872
  s_waitcnt lgkmcnt(8)
  v_mfma_f32_32x32x16_bf16 v[48:63], v[120:123], a[64:67], v[48:63]
  ds_read_b64_tr_b16 v[112:113], v7 offset:3136
  ds_read_b64_tr_b16 v[114:115], v7 offset:3904
  v_mfma_f32_32x32x16_bf16 v[64:79], v[124:127], a[64:67], v[64:79]
  s_add_u32 m0, s69, 57344
  s_add_u32 s70, s68, 65536
  buffer_load_dwordx4 v243, s[16:19], s70 offen  lds
  ds_read_b64_tr_b16 v[116:117], v7 offset:3168
  ds_read_b64_tr_b16 v[118:119], v7 offset:3936
  s_waitcnt lgkmcnt(8)
  v_mfma_f32_32x32x16_bf16 v[80:95], v[128:131], a[64:67], v[80:95]
  ds_read_b64_tr_b16 v[120:121], v7 offset:3200
  ds_read_b64_tr_b16 v[122:123], v7 offset:3968
  v_mfma_f32_32x32x16_bf16 v[96:111], v[132:135], a[64:67], v[96:111]
  ds_read_b64_tr_b16 v[124:125], v7 offset:3232
  ds_read_b64_tr_b16 v[126:127], v7 offset:4000
  s_waitcnt lgkmcnt(8)
  s_waitcnt vmcnt(35)
  v_mfma_f32_32x32x16_bf16 v[16:31], v[136:139], a[68:71], v[16:31]
  s_add_u32 m0, s69, 61440
  s_add_u32 s70, s68, 81920
  buffer_load_dwordx4 v243, s[16:19], s70 offen  lds
  ds_read_b64_tr_b16 v[128:129], v7 offset:6144
  ds_read_b64_tr_b16 v[130:131], v7 offset:6912
  v_mfma_f32_32x32x16_bf16 v[32:47], v[140:143], a[68:71], v[32:47]
  ds_read_b64_tr_b16 v[132:133], v7 offset:6176
  ds_read_b64_tr_b16 v[134:135], v7 offset:6944
  s_waitcnt lgkmcnt(8)
  v_mfma_f32_32x32x16_bf16 v[48:63], v[112:115], a[68:71], v[48:63]
  ds_read_b64_tr_b16 v[136:137], v7 offset:6208
  ds_read_b64_tr_b16 v[138:139], v7 offset:6976
  v_mfma_f32_32x32x16_bf16 v[64:79], v[116:119], a[68:71], v[64:79]
  s_add_u32 m0, s69, 65536
  s_add_u32 s70, s68, 98304
  buffer_load_dwordx4 v243, s[16:19], s70 offen  lds
  ds_read_b64_tr_b16 v[140:141], v7 offset:6240
  ds_read_b64_tr_b16 v[142:143], v7 offset:7008
  s_waitcnt lgkmcnt(8)
  v_mfma_f32_32x32x16_bf16 v[80:95], v[120:123], a[68:71], v[80:95]
  ds_read_b64_tr_b16 v[112:113], v7 offset:6272
  ds_read_b64_tr_b16 v[114:115], v7 offset:7040
  v_mfma_f32_32x32x16_bf16 v[96:111], v[124:127], a[68:71], v[96:111]
  ds_read_b64_tr_b16 v[116:117], v7 offset:6304
  ds_read_b64_tr_b16 v[118:119], v7 offset:7072
  s_waitcnt lgkmcnt(8)
  s_waitcnt vmcnt(36)
  v_mfma_f32_32x32x16_bf16 v[16:31], v[128:131], a[72:75], v[16:31]
  s_add_u32 m0, s69, 69632
  s_add_u32 s70, s68, 114688
  buffer_load_dwordx4 v243, s[16:19], s70 offen  lds
  ds_read_b64_tr_b16 v[120:121], v7 offset:9216
  ds_read_b64_tr_b16 v[122:123], v7 offset:9984
  v_mfma_f32_32x32x16_bf16 v[32:47], v[132:135], a[72:75], v[32:47]
  ds_read_b64_tr_b16 v[124:125], v7 offset:9248
  ds_read_b64_tr_b16 v[126:127], v7 offset:10016
  s_waitcnt lgkmcnt(8)
  v_mfma_f32_32x32x16_bf16 v[48:63], v[136:139], a[72:75], v[48:63]
  ds_read_b64_tr_b16 v[128:129], v7 offset:9280
  ds_read_b64_tr_b16 v[130:131], v7 offset:10048
  v_mfma_f32_32x32x16_bf16 v[64:79], v[140:143], a[72:75], v[64:79]
  s_add_u32 m0, s69, 73728
  s_add_u32 s70, s68, 131072
  buffer_load_dwordx4 v243, s[16:19], s70 offen  lds
  ds_read_b64_tr_b16 v[132:133], v7 offset:9312
  ds_read_b64_tr_b16 v[134:135], v7 offset:10080
  s_waitcnt lgkmcnt(8)
  v_mfma_f32_32x32x16_bf16 v[80:95], v[112:115], a[72:75], v[80:95]
  ds_read_b64_tr_b16 v[136:137], v7 offset:9344
  ds_read_b64_tr_b16 v[138:139], v7 offset:10112
  v_mfma_f32_32x32x16_bf16 v[96:111], v[116:119], a[72:75], v[96:111]
  ds_read_b64_tr_b16 v[140:141], v7 offset:9376
  ds_read_b64_tr_b16 v[142:143], v7 offset:10144
  s_waitcnt lgkmcnt(8)
  s_waitcnt vmcnt(37)
  v_mfma_f32_32x32x16_bf16 v[16:31], v[120:123], a[76:79], v[16:31]
  s_add_u32 m0, s69, 77824
  s_add_u32 s70, s68, 147456
  buffer_load_dwordx4 v243, s[16:19], s70 offen  lds
  ds_read_b64_tr_b16 v[112:113], v7 offset:24640
  ds_read_b64_tr_b16 v[114:115], v7 offset:25408
  v_mfma_f32_32x32x16_bf16 v[32:47], v[124:127], a[76:79], v[32:47]
  ds_read_b64_tr_b16 v[116:117], v7 offset:24672
  ds_read_b64_tr_b16 v[118:119], v7 offset:25440
  s_waitcnt lgkmcnt(8)
  v_mfma_f32_32x32x16_bf16 v[48:63], v[128:131], a[76:79], v[48:63]
  ds_read_b64_tr_b16 v[120:121], v7 offset:24704
  ds_read_b64_tr_b16 v[122:123], v7 offset:25472
  v_mfma_f32_32x32x16_bf16 v[64:79], v[132:135], a[76:79], v[64:79]
  s_add_u32 m0, s69, 81920
  s_add_u32 s70, s68, 163840
  buffer_load_dwordx4 v243, s[16:19], s70 offen  lds
  ds_read_b64_tr_b16 v[124:125], v7 offset:24736
  ds_read_b64_tr_b16 v[126:127], v7 offset:25504
  s_waitcnt lgkmcnt(8)
  v_mfma_f32_32x32x16_bf16 v[80:95], v[136:139], a[76:79], v[80:95]
  ds_read_b64_tr_b16 v[128:129], v7 offset:24768
  ds_read_b64_tr_b16 v[130:131], v7 offset:25536
  v_mfma_f32_32x32x16_bf16 v[96:111], v[140:143], a[76:79], v[96:111]
  ds_read_b64_tr_b16 v[132:133], v7 offset:24800
  ds_read_b64_tr_b16 v[134:135], v7 offset:25568
  s_waitcnt lgkmcnt(8)
  s_waitcnt vmcnt(38)
  v_mfma_f32_32x32x16_bf16 v[16:31], v[112:115], a[80:83], v[16:31]
  s_add_u32 m0, s69, 86016
  s_add_u32 s70, s68, 180224
  buffer_load_dwordx4 v243, s[16:19], s70 offen  lds
  ds_read_b64_tr_b16 v[136:137], v7 offset:27712
  ds_read_b64_tr_b16 v[138:139], v7 offset:28480
  v_mfma_f32_32x32x16_bf16 v[32:47], v[116:119], a[80:83], v[32:47]
  ds_read_b64_tr_b16 v[140:141], v7 offset:27744
  ds_read_b64_tr_b16 v[142:143], v7 offset:28512
  s_waitcnt lgkmcnt(8)
  v_mfma_f32_32x32x16_bf16 v[48:63], v[120:123], a[80:83], v[48:63]
  ds_read_b64_tr_b16 v[112:113], v7 offset:27776
  ds_read_b64_tr_b16 v[114:115], v7 offset:28544
  v_mfma_f32_32x32x16_bf16 v[64:79], v[124:127], a[80:83], v[64:79]
  s_add_u32 m0, s69, 90112
  s_add_u32 s70, s68, 196608
  buffer_load_dwordx4 v243, s[16:19], s70 offen  lds
  ds_read_b64_tr_b16 v[116:117], v7 offset:27808
  ds_read_b64_tr_b16 v[118:119], v7 offset:28576
  s_waitcnt lgkmcnt(8)
  v_mfma_f32_32x32x16_bf16 v[80:95], v[128:131], a[80:83], v[80:95]
  ds_read_b64_tr_b16 v[120:121], v7 offset:27840
  ds_read_b64_tr_b16 v[122:123], v7 offset:28608
  v_mfma_f32_32x32x16_bf16 v[96:111], v[132:135], a[80:83], v[96:111]
  ds_read_b64_tr_b16 v[124:125], v7 offset:27872
  ds_read_b64_tr_b16 v[126:127], v7 offset:28640
  s_waitcnt lgkmcnt(8)
  s_waitcnt vmcnt(39)
  v_mfma_f32_32x32x16_bf16 v[16:31], v[136:139], a[84:87], v[16:31]
  s_add_u32 m0, s69, 94208
  s_add_u32 s70, s68, 212992
  buffer_load_dwordx4 v243, s[16:19], s70 offen  lds
  ds_read_b64_tr_b16 v[128:129], v7 offset:30784
  ds_read_b64_tr_b16 v[130:131], v7 offset:31552
  v_mfma_f32_32x32x16_bf16 v[32:47], v[140:143], a[84:87], v[32:47]
  ds_read_b64_tr_b16 v[132:133], v7 offset:30816
  ds_read_b64_tr_b16 v[134:135], v7 offset:31584
  s_waitcnt lgkmcnt(8)
  v_mfma_f32_32x32x16_bf16 v[48:63], v[112:115], a[84:87], v[48:63]
  ds_read_b64_tr_b16 v[136:137], v7 offset:30848
  ds_read_b64_tr_b16 v[138:139], v7 offset:31616
  v_mfma_f32_32x32x16_bf16 v[64:79], v[116:119], a[84:87], v[64:79]
  ds_read_b64_tr_b16 v[140:141], v7 offset:30880
  ds_read_b64_tr_b16 v[142:143], v7 offset:31648
  s_waitcnt lgkmcnt(8)
  v_mfma_f32_32x32x16_bf16 v[80:95], v[120:123], a[84:87], v[80:95]
  ds_read_b64_tr_b16 v[112:113], v7 offset:30912
  ds_read_b64_tr_b16 v[114:115], v7 offset:31680
  v_mfma_f32_32x32x16_bf16 v[96:111], v[124:127], a[84:87], v[96:111]
  ds_read_b64_tr_b16 v[116:117], v7 offset:30944
  ds_read_b64_tr_b16 v[118:119], v7 offset:31712
  s_waitcnt lgkmcnt(8)
  s_waitcnt vmcnt(39)
  v_mfma_f32_32x32x16_bf16 v[16:31], v[128:131], a[88:91], v[16:31]
  ds_read_b64_tr_b16 v[120:121], v7 offset:33856
  ds_read_b64_tr_b16 v[122:123], v7 offset:34624
  v_mfma_f32_32x32x16_bf16 v[32:47], v[132:135], a[88:91], v[32:47]
  ds_read_b64_tr_b16 v[124:125], v7 offset:33888
  ds_read_b64_tr_b16 v[126:127], v7 offset:34656
  s_waitcnt lgkmcnt(8)
  v_mfma_f32_32x32x16_bf16 v[48:63], v[136:139], a[88:91], v[48:63]
  ds_read_b64_tr_b16 v[128:129], v7 offset:33920
  ds_read_b64_tr_b16 v[130:131], v7 offset:34688
  v_mfma_f32_32x32x16_bf16 v[64:79], v[140:143], a[88:91], v[64:79]
  ds_read_b64_tr_b16 v[132:133], v7 offset:33952
  ds_read_b64_tr_b16 v[134:135], v7 offset:34720
  s_waitcnt lgkmcnt(8)
  v_mfma_f32_32x32x16_bf16 v[80:95], v[112:115], a[88:91], v[80:95]
  ds_read_b64_tr_b16 v[136:137], v7 offset:33984
  ds_read_b64_tr_b16 v[138:139], v7 offset:34752
  v_mfma_f32_32x32x16_bf16 v[96:111], v[116:119], a[88:91], v[96:111]
  s_waitcnt vmcnt(24)
  s_barrier
  ds_read_b64_tr_b16 v[140:141], v7 offset:34016
  ds_read_b64_tr_b16 v[142:143], v7 offset:34784
  s_waitcnt lgkmcnt(8)
  v_mfma_f32_32x32x16_bf16 v[16:31], v[120:123], a[92:95], v[16:31]
  s_add_u32 m0, s69, 98304
  s_add_u32 s70, s68, 229376
  buffer_load_dwordx4 v243, s[16:19], s70 offen  lds
  ds_read_b64_tr_b16 v[112:113], v5 offset:0
  ds_read_b64_tr_b16 v[114:115], v5 offset:768
  v_mfma_f32_32x32x16_bf16 v[32:47], v[124:127], a[92:95], v[32:47]
  ds_read_b64_tr_b16 v[116:117], v5 offset:32
  ds_read_b64_tr_b16 v[118:119], v5 offset:800
  s_waitcnt lgkmcnt(8)
  v_mfma_f32_32x32x16_bf16 v[48:63], v[128:131], a[92:95], v[48:63]
  ds_read_b64_tr_b16 v[120:121], v5 offset:64
  ds_read_b64_tr_b16 v[122:123], v5 offset:832
  v_mfma_f32_32x32x16_bf16 v[64:79], v[132:135], a[92:95], v[64:79]
  s_add_u32 m0, s69, 102400
  s_add_u32 s70, s68, 245760
  buffer_load_dwordx4 v243, s[16:19], s70 offen  lds
  ds_read_b64_tr_b16 v[124:125], v5 offset:96
  ds_read_b64_tr_b16 v[126:127], v5 offset:864
  s_waitcnt lgkmcnt(8)
  v_mfma_f32_32x32x16_bf16 v[80:95], v[136:139], a[92:95], v[80:95]
  ds_read_b64_tr_b16 v[128:129], v5 offset:128
  ds_read_b64_tr_b16 v[130:131], v5 offset:896
  v_mfma_f32_32x32x16_bf16 v[96:111], v[140:143], a[92:95], v[96:111]
  ds_read_b64_tr_b16 v[132:133], v5 offset:160
  ds_read_b64_tr_b16 v[134:135], v5 offset:928
  s_waitcnt lgkmcnt(8)
  v_mfma_f32_32x32x16_bf16 v[16:31], v[112:115], a[96:99], v[16:31]
  s_add_u32 m0, s69, 106496
  s_add_u32 s70, s68, 262144
  buffer_load_dwordx4 v243, s[16:19], s70 offen  lds
  ds_read_b64_tr_b16 v[136:137], v5 offset:3072
  ds_read_b64_tr_b16 v[138:139], v5 offset:3840
  v_mfma_f32_32x32x16_bf16 v[32:47], v[116:119], a[96:99], v[32:47]
  ds_read_b64_tr_b16 v[140:141], v5 offset:3104
  ds_read_b64_tr_b16 v[142:143], v5 offset:3872
  s_waitcnt lgkmcnt(8)
  v_mfma_f32_32x32x16_bf16 v[48:63], v[120:123], a[96:99], v[48:63]
  ds_read_b64_tr_b16 v[112:113], v5 offset:3136
  ds_read_b64_tr_b16 v[114:115], v5 offset:3904
  v_mfma_f32_32x32x16_bf16 v[64:79], v[124:127], a[96:99], v[64:79]
  s_add_u32 m0, s69, 110592
  s_add_u32 s70, s68, 278528
  buffer_load_dwordx4 v243, s[16:19], s70 offen  lds
  ds_read_b64_tr_b16 v[116:117], v5 offset:3168
  ds_read_b64_tr_b16 v[118:119], v5 offset:3936
  s_waitcnt lgkmcnt(8)
  v_mfma_f32_32x32x16_bf16 v[80:95], v[128:131], a[96:99], v[80:95]
  ds_read_b64_tr_b16 v[120:121], v5 offset:3200
  ds_read_b64_tr_b16 v[122:123], v5 offset:3968
  v_mfma_f32_32x32x16_bf16 v[96:111], v[132:135], a[96:99], v[96:111]
  ds_read_b64_tr_b16 v[124:125], v5 offset:3232
  ds_read_b64_tr_b16 v[126:127], v5 offset:4000
  s_waitcnt lgkmcnt(8)
  v_mfma_f32_32x32x16_bf16 v[16:31], v[136:139], a[100:103], v[16:31]
  s_add_u32 m0, s69, 114688
  s_add_u32 s70, s68, 294912
  buffer_load_dwordx4 v243, s[16:19], s70 offen  lds
  ds_read_b64_tr_b16 v[128:129], v5 offset:6144
  ds_read_b64_tr_b16 v[130:131], v5 offset:6912
  v_mfma_f32_32x32x16_bf16 v[32:47], v[140:143], a[100:103], v[32:47]
  ds_read_b64_tr_b16 v[132:133], v5 offset:6176
  ds_read_b64_tr_b16 v[134:135], v5 offset:6944
  s_waitcnt lgkmcnt(8)
  v_mfma_f32_32x32x16_bf16 v[48:63], v[112:115], a[100:103], v[48:63]
  ds_read_b64_tr_b16 v[136:137], v5 offset:6208
  ds_read_b64_tr_b16 v[138:139], v5 offset:6976
  v_mfma_f32_32x32x16_bf16 v[64:79], v[116:119], a[100:103], v[64:79]
  s_add_u32 m0, s69, 118784
  s_add_u32 s70, s68, 311296
  buffer_load_dwordx4 v243, s[16:19], s70 offen  lds
  ds_read_b64_tr_b16 v[140:141], v5 offset:6240
  ds_read_b64_tr_b16 v[142:143], v5 offset:7008
  s_waitcnt lgkmcnt(8)
  v_mfma_f32_32x32x16_bf16 v[80:95], v[120:123], a[100:103], v[80:95]
  ds_read_b64_tr_b16 v[112:113], v5 offset:6272
  ds_read_b64_tr_b16 v[114:115], v5 offset:7040
  v_mfma_f32_32x32x16_bf16 v[96:111], v[124:127], a[100:103], v[96:111]
  ds_read_b64_tr_b16 v[116:117], v5 offset:6304
  ds_read_b64_tr_b16 v[118:119], v5 offset:7072
  s_waitcnt lgkmcnt(8)
  v_mfma_f32_32x32x16_bf16 v[16:31], v[128:131], a[104:107], v[16:31]
  ds_read_b64_tr_b16 v[120:121], v5 offset:9216
  ds_read_b64_tr_b16 v[122:123], v5 offset:9984
  v_mfma_f32_32x32x16_bf16 v[32:47], v[132:135], a[104:107], v[32:47]
  ds_read_b64_tr_b16 v[124:125], v5 offset:9248
  ds_read_b64_tr_b16 v[126:127], v5 offset:10016
  s_waitcnt lgkmcnt(8)
  v_mfma_f32_32x32x16_bf16 v[48:63], v[136:139], a[104:107], v[48:63]
  ds_read_b64_tr_b16 v[128:129], v5 offset:9280
  ds_read_b64_tr_b16 v[130:131], v5 offset:10048
  v_mfma_f32_32x32x16_bf16 v[64:79], v[140:143], a[104:107], v[64:79]
  ds_read_b64_tr_b16 v[132:133], v5 offset:9312
  ds_read_b64_tr_b16 v[134:135], v5 offset:10080
  s_waitcnt lgkmcnt(8)
  v_mfma_f32_32x32x16_bf16 v[80:95], v[112:115], a[104:107], v[80:95]
  ds_read_b64_tr_b16 v[136:137], v5 offset:9344
  ds_read_b64_tr_b16 v[138:139], v5 offset:10112
  v_mfma_f32_32x32x16_bf16 v[96:111], v[116:119], a[104:107], v[96:111]
  s_waitcnt vmcnt(24)
  s_barrier
  ds_read_b64_tr_b16 v[140:141], v5 offset:9376
  ds_read_b64_tr_b16 v[142:143], v5 offset:10144
  s_waitcnt lgkmcnt(8)
  v_mfma_f32_32x32x16_bf16 v[16:31], v[120:123], a[108:111], v[16:31]
  s_add_u32 m0, s69, 122880
  s_add_u32 s70, s68, 327680
  buffer_load_dwordx4 v243, s[16:19], s70 offen  lds
  ds_read_b64_tr_b16 v[112:113], v5 offset:24640
  ds_read_b64_tr_b16 v[114:115], v5 offset:25408
  v_mfma_f32_32x32x16_bf16 v[32:47], v[124:127], a[108:111], v[32:47]
  ds_read_b64_tr_b16 v[116:117], v5 offset:24672
  ds_read_b64_tr_b16 v[118:119], v5 offset:25440
  s_waitcnt lgkmcnt(8)
  v_mfma_f32_32x32x16_bf16 v[48:63], v[128:131], a[108:111], v[48:63]
  ds_read_b64_tr_b16 v[120:121], v5 offset:24704
  ds_read_b64_tr_b16 v[122:123], v5 offset:25472
  v_mfma_f32_32x32x16_bf16 v[64:79], v[132:135], a[108:111], v[64:79]
  s_add_u32 m0, s69, 126976
  s_add_u32 s70, s68, 344064
  buffer_load_dwordx4 v243, s[16:19], s70 offen  lds
  ds_read_b64_tr_b16 v[124:125], v5 offset:24736
  ds_read_b64_tr_b16 v[126:127], v5 offset:25504
  s_waitcnt lgkmcnt(8)
  v_mfma_f32_32x32x16_bf16 v[80:95], v[136:139], a[108:111], v[80:95]
  ds_read_b64_tr_b16 v[128:129], v5 offset:24768
  ds_read_b64_tr_b16 v[130:131], v5 offset:25536
  v_mfma_f32_32x32x16_bf16 v[96:111], v[140:143], a[108:111], v[96:111]
  ds_read_b64_tr_b16 v[132:133], v5 offset:24800
  ds_read_b64_tr_b16 v[134:135], v5 offset:25568
  s_waitcnt lgkmcnt(8)
  v_mfma_f32_32x32x16_bf16 v[16:31], v[112:115], a[112:115], v[16:31]
  s_add_u32 m0, s69, 131072
  s_add_u32 s70, s68, 360448
  buffer_load_dwordx4 v243, s[16:19], s70 offen  lds
  ds_read_b64_tr_b16 v[136:137], v5 offset:27712
  ds_read_b64_tr_b16 v[138:139], v5 offset:28480
  v_mfma_f32_32x32x16_bf16 v[32:47], v[116:119], a[112:115], v[32:47]
  ds_read_b64_tr_b16 v[140:141], v5 offset:27744
  ds_read_b64_tr_b16 v[142:143], v5 offset:28512
  s_waitcnt lgkmcnt(8)
  v_mfma_f32_32x32x16_bf16 v[48:63], v[120:123], a[112:115], v[48:63]
  ds_read_b64_tr_b16 v[112:113], v5 offset:27776
  ds_read_b64_tr_b16 v[114:115], v5 offset:28544
  v_mfma_f32_32x32x16_bf16 v[64:79], v[124:127], a[112:115], v[64:79]
  s_add_u32 m0, s69, 135168
  s_add_u32 s70, s68, 376832
  buffer_load_dwordx4 v243, s[16:19], s70 offen  lds
  ds_read_b64_tr_b16 v[116:117], v5 offset:27808
  ds_read_b64_tr_b16 v[118:119], v5 offset:28576
  s_waitcnt lgkmcnt(8)
  v_mfma_f32_32x32x16_bf16 v[80:95], v[128:131], a[112:115], v[80:95]
  ds_read_b64_tr_b16 v[120:121], v5 offset:27840
  ds_read_b64_tr_b16 v[122:123], v5 offset:28608
  v_mfma_f32_32x32x16_bf16 v[96:111], v[132:135], a[112:115], v[96:111]
  ds_read_b64_tr_b16 v[124:125], v5 offset:27872
  ds_read_b64_tr_b16 v[126:127], v5 offset:28640
  s_waitcnt lgkmcnt(8)
  v_mfma_f32_32x32x16_bf16 v[16:31], v[136:139], a[116:119], v[16:31]
  s_add_u32 m0, s69, 139264
  s_add_u32 s70, s68, 393216
  buffer_load_dwordx4 v243, s[16:19], s70 offen  lds
  ds_read_b64_tr_b16 v[128:129], v5 offset:30784
  ds_read_b64_tr_b16 v[130:131], v5 offset:31552
  v_mfma_f32_32x32x16_bf16 v[32:47], v[140:143], a[116:119], v[32:47]
  ds_read_b64_tr_b16 v[132:133], v5 offset:30816
  ds_read_b64_tr_b16 v[134:135], v5 offset:31584
  s_waitcnt lgkmcnt(8)
  v_mfma_f32_32x32x16_bf16 v[48:63], v[112:115], a[116:119], v[48:63]
  ds_read_b64_tr_b16 v[136:137], v5 offset:30848
  ds_read_b64_tr_b16 v[138:139], v5 offset:31616
  v_mfma_f32_32x32x16_bf16 v[64:79], v[116:119], a[116:119], v[64:79]
  s_add_u32 m0, s69, 143360
  s_add_u32 s70, s68, 409600
  buffer_load_dwordx4 v243, s[16:19], s70 offen  lds
  ds_read_b64_tr_b16 v[140:141], v5 offset:30880
  ds_read_b64_tr_b16 v[142:143], v5 offset:31648
  s_waitcnt lgkmcnt(8)
  v_mfma_f32_32x32x16_bf16 v[80:95], v[120:123], a[116:119], v[80:95]
  ds_read_b64_tr_b16 v[112:113], v5 offset:30912
  ds_read_b64_tr_b16 v[114:115], v5 offset:31680
  v_mfma_f32_32x32x16_bf16 v[96:111], v[124:127], a[116:119], v[96:111]
  ds_read_b64_tr_b16 v[116:117], v5 offset:30944
  ds_read_b64_tr_b16 v[118:119], v5 offset:31712
  s_waitcnt lgkmcnt(8)
  v_mfma_f32_32x32x16_bf16 v[16:31], v[128:131], a[120:123], v[16:31]
  s_add_u32 m0, s69, 147456
  s_add_u32 s70, s68, 425984
  buffer_load_dwordx4 v243, s[16:19], s70 offen  lds
  ds_read_b64_tr_b16 v[120:121], v5 offset:33856
  ds_read_b64_tr_b16 v[122:123], v5 offset:34624
  v_mfma_f32_32x32x16_bf16 v[32:47], v[132:135], a[120:123], v[32:47]
  ds_read_b64_tr_b16 v[124:125], v5 offset:33888
  ds_read_b64_tr_b16 v[126:127], v5 offset:34656
  s_waitcnt lgkmcnt(8)
  v_mfma_f32_32x32x16_bf16 v[48:63], v[136:139], a[120:123], v[48:63]
  ds_read_b64_tr_b16 v[128:129], v5 offset:33920
  ds_read_b64_tr_b16 v[130:131], v5 offset:34688
  v_mfma_f32_32x32x16_bf16 v[64:79], v[140:143], a[120:123], v[64:79]
  ds_read_b64_tr_b16 v[132:133], v5 offset:33952
  ds_read_b64_tr_b16 v[134:135], v5 offset:34720
  s_waitcnt lgkmcnt(8)
  v_mfma_f32_32x32x16_bf16 v[80:95], v[112:115], a[120:123], v[80:95]
  ds_read_b64_tr_b16 v[136:137], v5 offset:33984
  ds_read_b64_tr_b16 v[138:139], v5 offset:34752
  v_mfma_f32_32x32x16_bf16 v[96:111], v[116:119], a[120:123], v[96:111]
  ds_read_b64_tr_b16 v[140:141], v5 offset:34016
  ds_read_b64_tr_b16 v[142:143], v5 offset:34784
  s_waitcnt lgkmcnt(8)
  v_mfma_f32_32x32x16_bf16 v[16:31], v[120:123], a[124:127], v[16:31]
  v_mfma_f32_32x32x16_bf16 v[32:47], v[124:127], a[124:127], v[32:47]
  s_waitcnt lgkmcnt(4)
  v_mfma_f32_32x32x16_bf16 v[48:63], v[128:131], a[124:127], v[48:63]
  v_mfma_f32_32x32x16_bf16 v[64:79], v[132:135], a[124:127], v[64:79]
  s_waitcnt lgkmcnt(0)
  v_mfma_f32_32x32x16_bf16 v[80:95], v[136:139], a[124:127], v[80:95]
  v_mfma_f32_32x32x16_bf16 v[96:111], v[140:143], a[124:127], v[96:111]
.Lk3epi:
  s_nop 4
  v_exp_f32 v144, -v16
  v_exp_f32 v145, -v17
  v_exp_f32 v146, -v18
  v_exp_f32 v147, -v19
  v_exp_f32 v148, -v24
  v_exp_f32 v149, -v25
  v_exp_f32 v150, -v26
  v_exp_f32 v151, -v27
  v_pk_mul_f32 v[16:17], v[16:17], v[20:21]
  v_pk_mul_f32 v[18:19], v[18:19], v[22:23]
  v_pk_mul_f32 v[24:25], v[24:25], v[28:29]
  v_pk_mul_f32 v[26:27], v[26:27], v[30:31]
  v_pk_add_f32 v[144:145], v[144:145], 1.0 op_sel_hi:[1,0]
  v_pk_add_f32 v[146:147], v[146:147], 1.0 op_sel_hi:[1,0]
  v_pk_add_f32 v[148:149], v[148:149], 1.0 op_sel_hi:[1,0]
  v_pk_add_f32 v[150:151], v[150:151], 1.0 op_sel_hi:[1,0]
  v_rcp_f32 v144, v144
  v_rcp_f32 v145, v145
  v_rcp_f32 v146, v146
  v_rcp_f32 v147, v147
  v_rcp_f32 v148, v148
  v_rcp_f32 v149, v149
  v_rcp_f32 v150, v150
  v_rcp_f32 v151, v151
  v_pk_mul_f32 v[16:17], v[16:17], v[144:145]
  v_pk_mul_f32 v[18:19], v[18:19], v[146:147]
  v_pk_mul_f32 v[24:25], v[24:25], v[148:149]
  v_pk_mul_f32 v[26:27], v[26:27], v[150:151]
  v_cvt_pk_bf16_f32 v160, v16, v17
  v_cvt_pk_bf16_f32 v161, v18, v19
  v_cvt_pk_bf16_f32 v162, v24, v25
  v_cvt_pk_bf16_f32 v163, v26, v27
  buffer_store_dwordx4 v[160:163], v4, s[32:35], s47 offen offset:0 sc1
  v_exp_f32 v152, -v32
  v_exp_f32 v153, -v33
  v_exp_f32 v154, -v34
  v_exp_f32 v155, -v35
  v_exp_f32 v156, -v40
  v_exp_f32 v157, -v41
  v_exp_f32 v158, -v42
  v_exp_f32 v159, -v43
  v_pk_mul_f32 v[32:33], v[32:33], v[36:37]
  v_pk_mul_f32 v[34:35], v[34:35], v[38:39]
  v_pk_mul_f32 v[40:41], v[40:41], v[44:45]
  v_pk_mul_f32 v[42:43], v[42:43], v[46:47]
  v_pk_add_f32 v[152:153], v[152:153], 1.0 op_sel_hi:[1,0]
  v_pk_add_f32 v[154:155], v[154:155], 1.0 op_sel_hi:[1,0]
  v_pk_add_f32 v[156:157], v[156:157], 1.0 op_sel_hi:[1,0]
  v_pk_add_f32 v[158:159], v[158:159], 1.0 op_sel_hi:[1,0]
  v_rcp_f32 v152, v152
  v_rcp_f32 v153, v153
  v_rcp_f32 v154, v154
  v_rcp_f32 v155, v155
  v_rcp_f32 v156, v156
  v_rcp_f32 v157, v157
  v_rcp_f32 v158, v158
  v_rcp_f32 v159, v159
  v_pk_mul_f32 v[32:33], v[32:33], v[152:153]
  v_pk_mul_f32 v[34:35], v[34:35], v[154:155]
  v_pk_mul_f32 v[40:41], v[40:41], v[156:157]
  v_pk_mul_f32 v[42:43], v[42:43], v[158:159]
  v_cvt_pk_bf16_f32 v164, v32, v33
  v_cvt_pk_bf16_f32 v165, v34, v35
  v_cvt_pk_bf16_f32 v166, v40, v41
  v_cvt_pk_bf16_f32 v167, v42, v43
  buffer_store_dwordx4 v[164:167], v4, s[32:35], s47 offen offset:1024 sc1
  v_exp_f32 v144, -v48
  v_exp_f32 v145, -v49
  v_exp_f32 v146, -v50
  v_exp_f32 v147, -v51
  v_exp_f32 v148, -v56
  v_exp_f32 v149, -v57
  v_exp_f32 v150, -v58
  v_exp_f32 v151, -v59
  v_pk_mul_f32 v[48:49], v[48:49], v[52:53]
  v_pk_mul_f32 v[50:51], v[50:51], v[54:55]
  v_pk_mul_f32 v[56:57], v[56:57], v[60:61]
  v_pk_mul_f32 v[58:59], v[58:59], v[62:63]
  v_pk_add_f32 v[144:145], v[144:145], 1.0 op_sel_hi:[1,0]
  v_pk_add_f32 v[146:147], v[146:147], 1.0 op_sel_hi:[1,0]
  v_pk_add_f32 v[148:149], v[148:149], 1.0 op_sel_hi:[1,0]
  v_pk_add_f32 v[150:151], v[150:151], 1.0 op_sel_hi:[1,0]
  v_rcp_f32 v144, v144
  v_rcp_f32 v145, v145
  v_rcp_f32 v146, v146
  v_rcp_f32 v147, v147
  v_rcp_f32 v148, v148
  v_rcp_f32 v149, v149
  v_rcp_f32 v150, v150
  v_rcp_f32 v151, v151
  v_pk_mul_f32 v[48:49], v[48:49], v[144:145]
  v_pk_mul_f32 v[50:51], v[50:51], v[146:147]
  v_pk_mul_f32 v[56:57], v[56:57], v[148:149]
  v_pk_mul_f32 v[58:59], v[58:59], v[150:151]
  v_cvt_pk_bf16_f32 v160, v48, v49
  v_cvt_pk_bf16_f32 v161, v50, v51
  v_cvt_pk_bf16_f32 v162, v56, v57
  v_cvt_pk_bf16_f32 v163, v58, v59
  buffer_store_dwordx4 v[160:163], v4, s[32:35], s48 offen offset:0 sc1
  v_exp_f32 v152, -v64
  v_exp_f32 v153, -v65
  v_exp_f32 v154, -v66
  v_exp_f32 v155, -v67
  v_exp_f32 v156, -v72
  v_exp_f32 v157, -v73
  v_exp_f32 v158, -v74
  v_exp_f32 v159, -v75
  v_pk_mul_f32 v[64:65], v[64:65], v[68:69]
  v_pk_mul_f32 v[66:67], v[66:67], v[70:71]
  v_pk_mul_f32 v[72:73], v[72:73], v[76:77]
  v_pk_mul_f32 v[74:75], v[74:75], v[78:79]
  v_pk_add_f32 v[152:153], v[152:153], 1.0 op_sel_hi:[1,0]
  v_pk_add_f32 v[154:155], v[154:155], 1.0 op_sel_hi:[1,0]
  v_pk_add_f32 v[156:157], v[156:157], 1.0 op_sel_hi:[1,0]
  v_pk_add_f32 v[158:159], v[158:159], 1.0 op_sel_hi:[1,0]
  v_rcp_f32 v152, v152
  v_rcp_f32 v153, v153
  v_rcp_f32 v154, v154
  v_rcp_f32 v155, v155
  v_rcp_f32 v156, v156
  v_rcp_f32 v157, v157
  v_rcp_f32 v158, v158
  v_rcp_f32 v159, v159
  v_pk_mul_f32 v[64:65], v[64:65], v[152:153]
  v_pk_mul_f32 v[66:67], v[66:67], v[154:155]
  v_pk_mul_f32 v[72:73], v[72:73], v[156:157]
  v_pk_mul_f32 v[74:75], v[74:75], v[158:159]
  v_cvt_pk_bf16_f32 v164, v64, v65
  v_cvt_pk_bf16_f32 v165, v66, v67
  v_cvt_pk_bf16_f32 v166, v72, v73
  v_cvt_pk_bf16_f32 v167, v74, v75
  buffer_store_dwordx4 v[164:167], v4, s[32:35], s48 offen offset:1024 sc1
  v_exp_f32 v144, -v80
  v_exp_f32 v145, -v81
  v_exp_f32 v146, -v82
  v_exp_f32 v147, -v83
  v_exp_f32 v148, -v88
  v_exp_f32 v149, -v89
  v_exp_f32 v150, -v90
  v_exp_f32 v151, -v91
  v_pk_mul_f32 v[80:81], v[80:81], v[84:85]
  v_pk_mul_f32 v[82:83], v[82:83], v[86:87]
  v_pk_mul_f32 v[88:89], v[88:89], v[92:93]
  v_pk_mul_f32 v[90:91], v[90:91], v[94:95]
  v_pk_add_f32 v[144:145], v[144:145], 1.0 op_sel_hi:[1,0]
  v_pk_add_f32 v[146:147], v[146:147], 1.0 op_sel_hi:[1,0]
  v_pk_add_f32 v[148:149], v[148:149], 1.0 op_sel_hi:[1,0]
  v_pk_add_f32 v[150:151], v[150:151], 1.0 op_sel_hi:[1,0]
  v_rcp_f32 v144, v144
  v_rcp_f32 v145, v145
  v_rcp_f32 v146, v146
  v_rcp_f32 v147, v147
  v_rcp_f32 v148, v148
  v_rcp_f32 v149, v149
  v_rcp_f32 v150, v150
  v_rcp_f32 v151, v151
  v_pk_mul_f32 v[80:81], v[80:81], v[144:145]
  v_pk_mul_f32 v[82:83], v[82:83], v[146:147]
  v_pk_mul_f32 v[88:89], v[88:89], v[148:149]
  v_pk_mul_f32 v[90:91], v[90:91], v[150:151]
  v_cvt_pk_bf16_f32 v160, v80, v81
  v_cvt_pk_bf16_f32 v161, v82, v83
  v_cvt_pk_bf16_f32 v162, v88, v89
  v_cvt_pk_bf16_f32 v163, v90, v91
  buffer_store_dwordx4 v[160:163], v4, s[32:35], s51 offen offset:0 sc1
  v_exp_f32 v152, -v96
  v_exp_f32 v153, -v97
  v_exp_f32 v154, -v98
  v_exp_f32 v155, -v99
  v_exp_f32 v156, -v104
  v_exp_f32 v157, -v105
  v_exp_f32 v158, -v106
  v_exp_f32 v159, -v107
  v_pk_mul_f32 v[96:97], v[96:97], v[100:101]
  v_pk_mul_f32 v[98:99], v[98:99], v[102:103]
  v_pk_mul_f32 v[104:105], v[104:105], v[108:109]
  v_pk_mul_f32 v[106:107], v[106:107], v[110:111]
  v_pk_add_f32 v[152:153], v[152:153], 1.0 op_sel_hi:[1,0]
  v_pk_add_f32 v[154:155], v[154:155], 1.0 op_sel_hi:[1,0]
  v_pk_add_f32 v[156:157], v[156:157], 1.0 op_sel_hi:[1,0]
  v_pk_add_f32 v[158:159], v[158:159], 1.0 op_sel_hi:[1,0]
  v_rcp_f32 v152, v152
  v_rcp_f32 v153, v153
  v_rcp_f32 v154, v154
  v_rcp_f32 v155, v155
  v_rcp_f32 v156, v156
  v_rcp_f32 v157, v157
  v_rcp_f32 v158, v158
  v_rcp_f32 v159, v159
  v_pk_mul_f32 v[96:97], v[96:97], v[152:153]
  v_pk_mul_f32 v[98:99], v[98:99], v[154:155]
  v_pk_mul_f32 v[104:105], v[104:105], v[156:157]
  v_pk_mul_f32 v[106:107], v[106:107], v[158:159]
  v_cvt_pk_bf16_f32 v164, v96, v97
  v_cvt_pk_bf16_f32 v165, v98, v99
  v_cvt_pk_bf16_f32 v166, v104, v105
  v_cvt_pk_bf16_f32 v167, v106, v107
  buffer_store_dwordx4 v[164:167], v4, s[32:35], s51 offen offset:1024 sc1
  s_branch .k3done_27
.k3short_28:
  buffer_load_dwordx4 a[0:3], v4, s[32:35], s46 offen offset:0 sc1
  buffer_load_dwordx4 a[4:7], v4, s[32:35], s46 offen offset:1024 sc1
  buffer_load_dwordx4 a[8:11], v4, s[32:35], s46 offen offset:2048 sc1
  buffer_load_dwordx4 a[12:15], v4, s[32:35], s46 offen offset:3072 sc1
  s_add_u32 s46, s46, 4096
  buffer_load_dwordx4 a[16:19], v4, s[32:35], s46 offen offset:0 sc1
  buffer_load_dwordx4 a[20:23], v4, s[32:35], s46 offen offset:1024 sc1
  buffer_load_dwordx4 a[24:27], v4, s[32:35], s46 offen offset:2048 sc1
  buffer_load_dwordx4 a[28:31], v4, s[32:35], s46 offen offset:3072 sc1
  s_add_u32 s46, s46, 4096
  buffer_load_dwordx4 a[32:35], v4, s[32:35], s46 offen offset:0 sc1
  ds_read_b64_tr_b16 v[112:113], v5 offset:0
  ds_read_b64_tr_b16 v[114:115], v5 offset:768
  ds_read_b64_tr_b16 v[116:117], v5 offset:32
  ds_read_b64_tr_b16 v[118:119], v5 offset:800
  ds_read_b64_tr_b16 v[120:121], v5 offset:3072
  ds_read_b64_tr_b16 v[122:123], v5 offset:3840
  ds_read_b64_tr_b16 v[124:125], v5 offset:3104
  ds_read_b64_tr_b16 v[126:127], v5 offset:3872
  ds_read_b64_tr_b16 v[128:129], v5 offset:6144
  ds_read_b64_tr_b16 v[130:131], v5 offset:6912
  ds_read_b64_tr_b16 v[132:133], v5 offset:6176
  ds_read_b64_tr_b16 v[134:135], v5 offset:6944
  s_waitcnt lgkmcnt(8)
  s_waitcnt vmcnt(8)
  v_mfma_f32_32x32x16_bf16 v[16:31], v[112:115], a[0:3], 0
  buffer_load_dwordx4 a[36:39], v4, s[32:35], s46 offen offset:1024 sc1
  buffer_load_dwordx4 a[40:43], v4, s[32:35], s46 offen offset:2048 sc1
  ds_read_b64_tr_b16 v[136:137], v5 offset:9216
  ds_read_b64_tr_b16 v[138:139], v5 offset:9984
  v_mfma_f32_32x32x16_bf16 v[32:47], v[116:119], a[0:3], 0
  buffer_load_dwordx4 a[44:47], v4, s[32:35], s46 offen offset:3072 sc1
  ds_read_b64_tr_b16 v[140:141], v5 offset:9248
  ds_read_b64_tr_b16 v[142:143], v5 offset:10016
  s_waitcnt lgkmcnt(8)
  s_waitcnt vmcnt(10)
  v_mfma_f32_32x32x16_bf16 v[16:31], v[120:123], a[4:7], v[16:31]
  s_add_u32 s46, s46, 4096
  buffer_load_dwordx4 a[48:51], v4, s[32:35], s46 offen offset:0 sc1
  buffer_load_dwordx4 a[52:55], v4, s[32:35], s46 offen offset:1024 sc1
  ds_read_b64_tr_b16 v[112:113], v5 offset:24640
  ds_read_b64_tr_b16 v[114:115], v5 offset:25408
  v_mfma_f32_32x32x16_bf16 v[32:47], v[124:127], a[4:7], v[32:47]
  buffer_load_dwordx4 a[56:59], v4, s[32:35], s46 offen offset:2048 sc1
  ds_read_b64_tr_b16 v[116:117], v5 offset:24672
  ds_read_b64_tr_b16 v[118:119], v5 offset:25440
  s_waitcnt lgkmcnt(8)
  s_waitcnt vmcnt(12)
  v_mfma_f32_32x32x16_bf16 v[16:31], v[128:131], a[8:11], v[16:31]
  buffer_load_dwordx4 a[60:63], v4, s[32:35], s46 offen offset:3072 sc1
  s_add_u32 s46, s46, 4096
  buffer_load_dwordx4 a[64:67], v4, s[32:35], s46 offen offset:0 sc1
  ds_read_b64_tr_b16 v[120:121], v5 offset:27712
  ds_read_b64_tr_b16 v[122:123], v5 offset:28480
  v_mfma_f32_32x32x16_bf16 v[32:47], v[132:135], a[8:11], v[32:47]
  buffer_load_dwordx4 a[68:71], v4, s[32:35], s46 offen offset:1024 sc1
  ds_read_b64_tr_b16 v[124:125], v5 offset:27744
  ds_read_b64_tr_b16 v[126:127], v5 offset:28512
  s_waitcnt lgkmcnt(8)
  s_waitcnt vmcnt(14)
  v_mfma_f32_32x32x16_bf16 v[16:31], v[136:139], a[12:15], v[16:31]
  buffer_load_dwordx4 a[72:75], v4, s[32:35], s46 offen offset:2048 sc1
  buffer_load_dwordx4 a[76:79], v4, s[32:35], s46 offen offset:3072 sc1
  ds_read_b64_tr_b16 v[128:129], v5 offset:30784
  ds_read_b64_tr_b16 v[130:131], v5 offset:31552
  v_mfma_f32_32x32x16_bf16 v[32:47], v[140:143], a[12:15], v[32:47]
  s_add_u32 s46, s46, 4096
  buffer_load_dwordx4 a[80:83], v4, s[32:35], s46 offen offset:0 sc1
  ds_read_b64_tr_b16 v[132:133], v5 offset:30816
  ds_read_b64_tr_b16 v[134:135], v5 offset:31584
  s_waitcnt lgkmcnt(8)
  s_waitcnt vmcnt(16)
  v_mfma_f32_32x32x16_bf16 v[16:31], v[112:115], a[16:19], v[16:31]
  buffer_load_dwordx4 a[84:87], v4, s[32:35], s46 offen offset:1024 sc1
  buffer_load_dwordx4 a[88:91], v4, s[32:35], s46 offen offset:2048 sc1
  ds_read_b64_tr_b16 v[136:137], v5 offset:33856
  ds_read_b64_tr_b16 v[138:139], v5 offset:34624
  v_mfma_f32_32x32x16_bf16 v[32:47], v[116:119], a[16:19], v[32:47]
  buffer_load_dwordx4 a[92:95], v4, s[32:35], s46 offen offset:3072 sc1
  ds_read_b64_tr_b16 v[140:141], v5 offset:33888
  ds_read_b64_tr_b16 v[142:143], v5 offset:34656
  s_waitcnt lgkmcnt(8)
  s_waitcnt vmcnt(18)
  v_mfma_f32_32x32x16_bf16 v[16:31], v[120:123], a[20:23], v[16:31]
  s_add_u32 s46, s46, 4096
  buffer_load_dwordx4 a[96:99], v4, s[32:35], s46 offen offset:0 sc1
  buffer_load_dwordx4 a[100:103], v4, s[32:35], s46 offen offset:1024 sc1
  ds_read_b64_tr_b16 v[112:113], v6 offset:0
  ds_read_b64_tr_b16 v[114:115], v6 offset:768
  v_mfma_f32_32x32x16_bf16 v[32:47], v[124:127], a[20:23], v[32:47]
  buffer_load_dwordx4 a[104:107], v4, s[32:35], s46 offen offset:2048 sc1
  ds_read_b64_tr_b16 v[116:117], v6 offset:32
  ds_read_b64_tr_b16 v[118:119], v6 offset:800
  s_waitcnt lgkmcnt(8)
  s_waitcnt vmcnt(20)
  v_mfma_f32_32x32x16_bf16 v[16:31], v[128:131], a[24:27], v[16:31]
  buffer_load_dwordx4 a[108:111], v4, s[32:35], s46 offen offset:3072 sc1
  s_add_u32 s46, s46, 4096
  buffer_load_dwordx4 a[112:115], v4, s[32:35], s46 offen offset:0 sc1
  ds_read_b64_tr_b16 v[120:121], v6 offset:3072
  ds_read_b64_tr_b16 v[122:123], v6 offset:3840
  v_mfma_f32_32x32x16_bf16 v[32:47], v[132:135], a[24:27], v[32:47]
  buffer_load_dwordx4 a[116:119], v4, s[32:35], s46 offen offset:1024 sc1
  ds_read_b64_tr_b16 v[124:125], v6 offset:3104
  ds_read_b64_tr_b16 v[126:127], v6 offset:3872
  s_waitcnt lgkmcnt(8)
  s_waitcnt vmcnt(22)
  v_mfma_f32_32x32x16_bf16 v[16:31], v[136:139], a[28:31], v[16:31]
  buffer_load_dwordx4 a[120:123], v4, s[32:35], s46 offen offset:2048 sc1
  buffer_load_dwordx4 a[124:127], v4, s[32:35], s46 offen offset:3072 sc1
  ds_read_b64_tr_b16 v[128:129], v6 offset:6144
  ds_read_b64_tr_b16 v[130:131], v6 offset:6912
  v_mfma_f32_32x32x16_bf16 v[32:47], v[140:143], a[28:31], v[32:47]
  s_barrier
  ds_read_b64_tr_b16 v[132:133], v6 offset:6176
  ds_read_b64_tr_b16 v[134:135], v6 offset:6944
  s_waitcnt lgkmcnt(8)
  s_waitcnt vmcnt(23)
  v_mfma_f32_32x32x16_bf16 v[16:31], v[112:115], a[32:35], v[16:31]
  s_add_u32 m0, s67, 0
  s_add_u32 s75, s66, 1056768
  buffer_load_dwordx4 v240, s[8:11], s75 offen  lds
  s_add_u32 m0, s67, 1024
  s_nop 0
  buffer_load_dwordx4 v241, s[8:11], s75 offen  lds
  ds_read_b64_tr_b16 v[136:137], v6 offset:9216
  ds_read_b64_tr_b16 v[138:139], v6 offset:9984
  v_mfma_f32_32x32x16_bf16 v[32:47], v[116:119], a[32:35], v[32:47]
  s_add_u32 m0, s67, 2048
  s_nop 0
  buffer_load_dwordx4 v242, s[8:11], s75 offen  lds
  ds_read_b64_tr_b16 v[140:141], v6 offset:9248
  ds_read_b64_tr_b16 v[142:143], v6 offset:10016
  s_waitcnt lgkmcnt(8)
  s_waitcnt vmcnt(25)
  v_mfma_f32_32x32x16_bf16 v[16:31], v[120:123], a[36:39], v[16:31]
  s_add_u32 m0, s67, 12320
  s_nop 0
  buffer_load_dwordx4 v240, s[12:15], s75 offen  lds
  s_add_u32 m0, s67, 13344
  s_nop 0
  buffer_load_dwordx4 v241, s[12:15], s75 offen  lds
  ds_read_b64_tr_b16 v[112:113], v6 offset:24640
  ds_read_b64_tr_b16 v[114:115], v6 offset:25408
  v_mfma_f32_32x32x16_bf16 v[32:47], v[124:127], a[36:39], v[32:47]
  s_add_u32 m0, s67, 14368
  s_nop 0
  buffer_load_dwordx4 v242, s[12:15], s75 offen  lds
  ds_read_b64_tr_b16 v[116:117], v6 offset:24672
  ds_read_b64_tr_b16 v[118:119], v6 offset:25440
  s_waitcnt lgkmcnt(8)
  s_waitcnt vmcnt(27)
  v_mfma_f32_32x32x16_bf16 v[16:31], v[128:131], a[40:43], v[16:31]
  s_add_u32 m0, s67, 24640
  s_add_u32 s75, s66, 1232896
  buffer_load_dwordx4 v240, s[8:11], s75 offen  lds
  s_add_u32 m0, s67, 25664
  s_nop 0
  buffer_load_dwordx4 v241, s[8:11], s75 offen  lds
  ds_read_b64_tr_b16 v[120:121], v6 offset:27712
  ds_read_b64_tr_b16 v[122:123], v6 offset:28480
  v_mfma_f32_32x32x16_bf16 v[32:47], v[132:135], a[40:43], v[32:47]
  s_add_u32 m0, s67, 26688
  s_nop 0
  buffer_load_dwordx4 v242, s[8:11], s75 offen  lds
  ds_read_b64_tr_b16 v[124:125], v6 offset:27744
  ds_read_b64_tr_b16 v[126:127], v6 offset:28512
  s_waitcnt lgkmcnt(8)
  s_waitcnt vmcnt(29)
  v_mfma_f32_32x32x16_bf16 v[16:31], v[136:139], a[44:47], v[16:31]
  s_add_u32 m0, s67, 36960
  s_nop 0
  buffer_load_dwordx4 v240, s[12:15], s75 offen  lds
  s_add_u32 m0, s67, 37984
  s_nop 0
  buffer_load_dwordx4 v241, s[12:15], s75 offen  lds
  ds_read_b64_tr_b16 v[128:129], v6 offset:30784
  ds_read_b64_tr_b16 v[130:131], v6 offset:31552
  v_mfma_f32_32x32x16_bf16 v[32:47], v[140:143], a[44:47], v[32:47]
  s_add_u32 m0, s67, 39008
  s_nop 0
  buffer_load_dwordx4 v242, s[12:15], s75 offen  lds
  ds_read_b64_tr_b16 v[132:133], v6 offset:30816
  ds_read_b64_tr_b16 v[134:135], v6 offset:31584
  s_waitcnt lgkmcnt(8)
  s_waitcnt vmcnt(31)
  v_mfma_f32_32x32x16_bf16 v[16:31], v[112:115], a[48:51], v[16:31]
  buffer_store_dwordx2 v[168:169], v176, s[32:35], s80 offen offset:0 sc1
  buffer_store_dwordx2 v[170:171], v176, s[32:35], s80 offen offset:512 sc1
  ds_read_b64_tr_b16 v[136:137], v6 offset:33856
  ds_read_b64_tr_b16 v[138:139], v6 offset:34624
  v_mfma_f32_32x32x16_bf16 v[32:47], v[116:119], a[48:51], v[32:47]
  buffer_store_dwordx2 v[172:173], v176, s[32:35], s81 offen offset:0 sc1
  ds_read_b64_tr_b16 v[140:141], v6 offset:33888
  ds_read_b64_tr_b16 v[142:143], v6 offset:34656
  s_waitcnt lgkmcnt(8)
  s_waitcnt vmcnt(33)
  v_mfma_f32_32x32x16_bf16 v[16:31], v[120:123], a[52:55], v[16:31]
  buffer_store_dwordx2 v[174:175], v176, s[32:35], s81 offen offset:512 sc1
  s_add_u32 m0, s69, 151552
  s_add_u32 s70, s68, 0
  buffer_load_dwordx4 v243, s[16:19], s70 offen  lds
  ds_read_b64_tr_b16 v[112:113], v7 offset:0
  ds_read_b64_tr_b16 v[114:115], v7 offset:768
  v_mfma_f32_32x32x16_bf16 v[32:47], v[124:127], a[52:55], v[32:47]
  s_add_u32 m0, s69, 155648
  s_add_u32 s70, s68, 16384
  buffer_load_dwordx4 v243, s[16:19], s70 offen  lds
  ds_read_b64_tr_b16 v[116:117], v7 offset:32
  ds_read_b64_tr_b16 v[118:119], v7 offset:800
  s_waitcnt lgkmcnt(8)
  s_waitcnt vmcnt(35)
  v_mfma_f32_32x32x16_bf16 v[16:31], v[128:131], a[56:59], v[16:31]
  s_add_u32 m0, s69, 159744
  s_add_u32 s70, s68, 32768
  buffer_load_dwordx4 v243, s[16:19], s70 offen  lds
  ds_read_b64_tr_b16 v[120:121], v7 offset:3072
  ds_read_b64_tr_b16 v[122:123], v7 offset:3840
  v_mfma_f32_32x32x16_bf16 v[32:47], v[132:135], a[56:59], v[32:47]
  ds_read_b64_tr_b16 v[124:125], v7 offset:3104
  ds_read_b64_tr_b16 v[126:127], v7 offset:3872
  s_waitcnt lgkmcnt(8)
  s_waitcnt vmcnt(35)
  v_mfma_f32_32x32x16_bf16 v[16:31], v[136:139], a[60:63], v[16:31]
  ds_read_b64_tr_b16 v[128:129], v7 offset:6144
  ds_read_b64_tr_b16 v[130:131], v7 offset:6912
  v_mfma_f32_32x32x16_bf16 v[32:47], v[140:143], a[60:63], v[32:47]
  s_barrier
  ds_read_b64_tr_b16 v[132:133], v7 offset:6176
  ds_read_b64_tr_b16 v[134:135], v7 offset:6944
  s_waitcnt lgkmcnt(8)
  s_waitcnt vmcnt(34)
  v_mfma_f32_32x32x16_bf16 v[16:31], v[112:115], a[64:67], v[16:31]
  s_add_u32 m0, s69, 53248
  s_add_u32 s70, s68, 49152
  buffer_load_dwordx4 v243, s[16:19], s70 offen  lds
  ds_read_b64_tr_b16 v[136:137], v7 offset:9216
  ds_read_b64_tr_b16 v[138:139], v7 offset:9984
  v_mfma_f32_32x32x16_bf16 v[32:47], v[116:119], a[64:67], v[32:47]
  s_add_u32 m0, s69, 57344
  s_add_u32 s70, s68, 65536
  buffer_load_dwordx4 v243, s[16:19], s70 offen  lds
  ds_read_b64_tr_b16 v[140:141], v7 offset:9248
  ds_read_b64_tr_b16 v[142:143], v7 offset:10016
  s_waitcnt lgkmcnt(8)
  s_waitcnt vmcnt(35)
  v_mfma_f32_32x32x16_bf16 v[16:31], v[120:123], a[68:71], v[16:31]
  s_add_u32 m0, s69, 61440
  s_add_u32 s70, s68, 81920
  buffer_load_dwordx4 v243, s[16:19], s70 offen  lds
  ds_read_b64_tr_b16 v[112:113], v7 offset:24640
  ds_read_b64_tr_b16 v[114:115], v7 offset:25408
  v_mfma_f32_32x32x16_bf16 v[32:47], v[124:127], a[68:71], v[32:47]
  s_add_u32 m0, s69, 65536
  s_add_u32 s70, s68, 98304
  buffer_load_dwordx4 v243, s[16:19], s70 offen  lds
  ds_read_b64_tr_b16 v[116:117], v7 offset:24672
  ds_read_b64_tr_b16 v[118:119], v7 offset:25440
  s_waitcnt lgkmcnt(8)
  s_waitcnt vmcnt(36)
  v_mfma_f32_32x32x16_bf16 v[16:31], v[128:131], a[72:75], v[16:31]
  s_add_u32 m0, s69, 69632
  s_add_u32 s70, s68, 114688
  buffer_load_dwordx4 v243, s[16:19], s70 offen  lds
  ds_read_b64_tr_b16 v[120:121], v7 offset:27712
  ds_read_b64_tr_b16 v[122:123], v7 offset:28480
  v_mfma_f32_32x32x16_bf16 v[32:47], v[132:135], a[72:75], v[32:47]
  s_add_u32 m0, s69, 73728
  s_add_u32 s70, s68, 131072
  buffer_load_dwordx4 v243, s[16:19], s70 offen  lds
  ds_read_b64_tr_b16 v[124:125], v7 offset:27744
  ds_read_b64_tr_b16 v[126:127], v7 offset:28512
  s_waitcnt lgkmcnt(8)
  s_waitcnt vmcnt(37)
  v_mfma_f32_32x32x16_bf16 v[16:31], v[136:139], a[76:79], v[16:31]
  s_add_u32 m0, s69, 77824
  s_add_u32 s70, s68, 147456
  buffer_load_dwordx4 v243, s[16:19], s70 offen  lds
  ds_read_b64_tr_b16 v[128:129], v7 offset:30784
  ds_read_b64_tr_b16 v[130:131], v7 offset:31552
  v_mfma_f32_32x32x16_bf16 v[32:47], v[140:143], a[76:79], v[32:47]
  s_add_u32 m0, s69, 81920
  s_add_u32 s70, s68, 163840
  buffer_load_dwordx4 v243, s[16:19], s70 offen  lds
  ds_read_b64_tr_b16 v[132:133], v7 offset:30816
  ds_read_b64_tr_b16 v[134:135], v7 offset:31584
  s_waitcnt lgkmcnt(8)
  s_waitcnt vmcnt(38)
  v_mfma_f32_32x32x16_bf16 v[16:31], v[112:115], a[80:83], v[16:31]
  s_add_u32 m0, s69, 86016
  s_add_u32 s70, s68, 180224
  buffer_load_dwordx4 v243, s[16:19], s70 offen  lds
  ds_read_b64_tr_b16 v[136:137], v7 offset:33856
  ds_read_b64_tr_b16 v[138:139], v7 offset:34624
  v_mfma_f32_32x32x16_bf16 v[32:47], v[116:119], a[80:83], v[32:47]
  s_add_u32 m0, s69, 90112
  s_add_u32 s70, s68, 196608
  buffer_load_dwordx4 v243, s[16:19], s70 offen  lds
  s_waitcnt vmcnt(23)
  s_barrier
  ds_read_b64_tr_b16 v[140:141], v7 offset:33888
  ds_read_b64_tr_b16 v[142:143], v7 offset:34656
  s_waitcnt lgkmcnt(8)
  v_mfma_f32_32x32x16_bf16 v[16:31], v[120:123], a[84:87], v[16:31]
  s_add_u32 m0, s69, 94208
  s_add_u32 s70, s68, 212992
  buffer_load_dwordx4 v243, s[16:19], s70 offen  lds
  ds_read_b64_tr_b16 v[112:113], v5 offset:0
  ds_read_b64_tr_b16 v[114:115], v5 offset:768
  v_mfma_f32_32x32x16_bf16 v[32:47], v[124:127], a[84:87], v[32:47]
  s_add_u32 m0, s69, 98304
  s_add_u32 s70, s68, 229376
  buffer_load_dwordx4 v243, s[16:19], s70 offen  lds
  ds_read_b64_tr_b16 v[116:117], v5 offset:32
  ds_read_b64_tr_b16 v[118:119], v5 offset:800
  s_waitcnt lgkmcnt(8)
  v_mfma_f32_32x32x16_bf16 v[16:31], v[128:131], a[88:91], v[16:31]
  s_add_u32 m0, s69, 102400
  s_add_u32 s70, s68, 245760
  buffer_load_dwordx4 v243, s[16:19], s70 offen  lds
  ds_read_b64_tr_b16 v[120:121], v5 offset:3072
  ds_read_b64_tr_b16 v[122:123], v5 offset:3840
  v_mfma_f32_32x32x16_bf16 v[32:47], v[132:135], a[88:91], v[32:47]
  s_add_u32 m0, s69, 106496
  s_add_u32 s70, s68, 262144
  buffer_load_dwordx4 v243, s[16:19], s70 offen  lds
  ds_read_b64_tr_b16 v[124:125], v5 offset:3104
  ds_read_b64_tr_b16 v[126:127], v5 offset:3872
  s_waitcnt lgkmcnt(8)
  v_mfma_f32_32x32x16_bf16 v[16:31], v[136:139], a[92:95], v[16:31]
  s_add_u32 m0, s69, 110592
  s_add_u32 s70, s68, 278528
  buffer_load_dwordx4 v243, s[16:19], s70 offen  lds
  ds_read_b64_tr_b16 v[128:129], v5 offset:6144
  ds_read_b64_tr_b16 v[130:131], v5 offset:6912
  v_mfma_f32_32x32x16_bf16 v[32:47], v[140:143], a[92:95], v[32:47]
  s_add_u32 m0, s69, 114688
  s_add_u32 s70, s68, 294912
  buffer_load_dwordx4 v243, s[16:19], s70 offen  lds
  ds_read_b64_tr_b16 v[132:133], v5 offset:6176
  ds_read_b64_tr_b16 v[134:135], v5 offset:6944
  s_waitcnt lgkmcnt(8)
  v_mfma_f32_32x32x16_bf16 v[16:31], v[112:115], a[96:99], v[16:31]
  s_add_u32 m0, s69, 118784
  s_add_u32 s70, s68, 311296
  buffer_load_dwordx4 v243, s[16:19], s70 offen  lds
  ds_read_b64_tr_b16 v[136:137], v5 offset:9216
  ds_read_b64_tr_b16 v[138:139], v5 offset:9984
  v_mfma_f32_32x32x16_bf16 v[32:47], v[116:119], a[96:99], v[32:47]
  s_waitcnt vmcnt(24)
  s_barrier
  ds_read_b64_tr_b16 v[140:141], v5 offset:9248
  ds_read_b64_tr_b16 v[142:143], v5 offset:10016
  s_waitcnt lgkmcnt(8)
  v_mfma_f32_32x32x16_bf16 v[16:31], v[120:123], a[100:103], v[16:31]
  s_add_u32 m0, s69, 122880
  s_add_u32 s70, s68, 327680
  buffer_load_dwordx4 v243, s[16:19], s70 offen  lds
  ds_read_b64_tr_b16 v[112:113], v5 offset:24640
  ds_read_b64_tr_b16 v[114:115], v5 offset:25408
  v_mfma_f32_32x32x16_bf16 v[32:47], v[124:127], a[100:103], v[32:47]
  s_add_u32 m0, s69, 126976
  s_add_u32 s70, s68, 344064
  buffer_load_dwordx4 v243, s[16:19], s70 offen  lds
  ds_read_b64_tr_b16 v[116:117], v5 offset:24672
  ds_read_b64_tr_b16 v[118:119], v5 offset:25440
  s_waitcnt lgkmcnt(8)
  v_mfma_f32_32x32x16_bf16 v[16:31], v[128:131], a[104:107], v[16:31]
  s_add_u32 m0, s69, 131072
  s_add_u32 s70, s68, 360448
  buffer_load_dwordx4 v243, s[16:19], s70 offen  lds
  ds_read_b64_tr_b16 v[120:121], v5 offset:27712
  ds_read_b64_tr_b16 v[122:123], v5 offset:28480
  v_mfma_f32_32x32x16_bf16 v[32:47], v[132:135], a[104:107], v[32:47]
  s_add_u32 m0, s69, 135168
  s_add_u32 s70, s68, 376832
  buffer_load_dwordx4 v243, s[16:19], s70 offen  lds
  ds_read_b64_tr_b16 v[124:125], v5 offset:27744
  ds_read_b64_tr_b16 v[126:127], v5 offset:28512
  s_waitcnt lgkmcnt(8)
  v_mfma_f32_32x32x16_bf16 v[16:31], v[136:139], a[108:111], v[16:31]
  s_add_u32 m0, s69, 139264
  s_add_u32 s70, s68, 393216
  buffer_load_dwordx4 v243, s[16:19], s70 offen  lds
  ds_read_b64_tr_b16 v[128:129], v5 offset:30784
  ds_read_b64_tr_b16 v[130:131], v5 offset:31552
  v_mfma_f32_32x32x16_bf16 v[32:47], v[140:143], a[108:111], v[32:47]
  s_add_u32 m0, s69, 143360
  s_add_u32 s70, s68, 409600
  buffer_load_dwordx4 v243, s[16:19], s70 offen  lds
  ds_read_b64_tr_b16 v[132:133], v5 offset:30816
  ds_read_b64_tr_b16 v[134:135], v5 offset:31584
  s_waitcnt lgkmcnt(8)
  v_mfma_f32_32x32x16_bf16 v[16:31], v[112:115], a[112:115], v[16:31]
  s_add_u32 m0, s69, 147456
  s_add_u32 s70, s68, 425984
  buffer_load_dwordx4 v243, s[16:19], s70 offen  lds
  ds_read_b64_tr_b16 v[136:137], v5 offset:33856
  ds_read_b64_tr_b16 v[138:139], v5 offset:34624
  v_mfma_f32_32x32x16_bf16 v[32:47], v[116:119], a[112:115], v[32:47]
  ds_read_b64_tr_b16 v[140:141], v5 offset:33888
  ds_read_b64_tr_b16 v[142:143], v5 offset:34656
  s_waitcnt lgkmcnt(8)
  v_mfma_f32_32x32x16_bf16 v[16:31], v[120:123], a[116:119], v[16:31]
  v_mfma_f32_32x32x16_bf16 v[32:47], v[124:127], a[116:119], v[32:47]
  s_waitcnt lgkmcnt(4)
  v_mfma_f32_32x32x16_bf16 v[16:31], v[128:131], a[120:123], v[16:31]
  v_mfma_f32_32x32x16_bf16 v[32:47], v[132:135], a[120:123], v[32:47]
  s_waitcnt lgkmcnt(0)
  v_mfma_f32_32x32x16_bf16 v[16:31], v[136:139], a[124:127], v[16:31]
  v_mfma_f32_32x32x16_bf16 v[32:47], v[140:143], a[124:127], v[32:47]
  s_nop 10
  v_exp_f32 v144, -v16
  v_exp_f32 v145, -v17
  v_exp_f32 v146, -v18
  v_exp_f32 v147, -v19
  v_exp_f32 v148, -v24
  v_exp_f32 v149, -v25
  v_exp_f32 v150, -v26
  v_exp_f32 v151, -v27
  v_pk_mul_f32 v[16:17], v[16:17], v[20:21]
  v_pk_mul_f32 v[18:19], v[18:19], v[22:23]
  v_pk_mul_f32 v[24:25], v[24:25], v[28:29]
  v_pk_mul_f32 v[26:27], v[26:27], v[30:31]
  v_pk_add_f32 v[144:145], v[144:145], 1.0 op_sel_hi:[1,0]
  v_pk_add_f32 v[146:147], v[146:147], 1.0 op_sel_hi:[1,0]
  v_pk_add_f32 v[148:149], v[148:149], 1.0 op_sel_hi:[1,0]
  v_pk_add_f32 v[150:151], v[150:151], 1.0 op_sel_hi:[1,0]
  v_rcp_f32 v144, v144
  v_rcp_f32 v145, v145
  v_rcp_f32 v146, v146
  v_rcp_f32 v147, v147
  v_rcp_f32 v148, v148
  v_rcp_f32 v149, v149
  v_rcp_f32 v150, v150
  v_rcp_f32 v151, v151
  v_pk_mul_f32 v[16:17], v[16:17], v[144:145]
  v_pk_mul_f32 v[18:19], v[18:19], v[146:147]
  v_pk_mul_f32 v[24:25], v[24:25], v[148:149]
  v_pk_mul_f32 v[26:27], v[26:27], v[150:151]
  v_cvt_pk_bf16_f32 v160, v16, v17
  v_cvt_pk_bf16_f32 v161, v18, v19
  v_cvt_pk_bf16_f32 v162, v24, v25
  v_cvt_pk_bf16_f32 v163, v26, v27
  buffer_store_dwordx4 v[160:163], v4, s[32:35], s47 offen offset:0 sc1
  v_exp_f32 v152, -v32
  v_exp_f32 v153, -v33
  v_exp_f32 v154, -v34
  v_exp_f32 v155, -v35
  v_exp_f32 v156, -v40
  v_exp_f32 v157, -v41
  v_exp_f32 v158, -v42
  v_exp_f32 v159, -v43
  v_pk_mul_f32 v[32:33], v[32:33], v[36:37]
  v_pk_mul_f32 v[34:35], v[34:35], v[38:39]
  v_pk_mul_f32 v[40:41], v[40:41], v[44:45]
  v_pk_mul_f32 v[42:43], v[42:43], v[46:47]
  v_pk_add_f32 v[152:153], v[152:153], 1.0 op_sel_hi:[1,0]
  v_pk_add_f32 v[154:155], v[154:155], 1.0 op_sel_hi:[1,0]
  v_pk_add_f32 v[156:157], v[156:157], 1.0 op_sel_hi:[1,0]
  v_pk_add_f32 v[158:159], v[158:159], 1.0 op_sel_hi:[1,0]
  v_rcp_f32 v152, v152
  v_rcp_f32 v153, v153
  v_rcp_f32 v154, v154
  v_rcp_f32 v155, v155
  v_rcp_f32 v156, v156
  v_rcp_f32 v157, v157
  v_rcp_f32 v158, v158
  v_rcp_f32 v159, v159
  v_pk_mul_f32 v[32:33], v[32:33], v[152:153]
  v_pk_mul_f32 v[34:35], v[34:35], v[154:155]
  v_pk_mul_f32 v[40:41], v[40:41], v[156:157]
  v_pk_mul_f32 v[42:43], v[42:43], v[158:159]
  v_cvt_pk_bf16_f32 v164, v32, v33
  v_cvt_pk_bf16_f32 v165, v34, v35
  v_cvt_pk_bf16_f32 v166, v40, v41
  v_cvt_pk_bf16_f32 v167, v42, v43
  buffer_store_dwordx4 v[164:167], v4, s[32:35], s47 offen offset:1024 sc1
  s_branch .k3done_27
.k3idle_22:
  s_waitcnt vmcnt(0)
  s_barrier
  s_lshl_b32 s49, s36, 2
  s_add_u32 s49, s49, s3
  s_mul_i32 s49, s49, 22016
  v_lshlrev_b32 v246, 7, v1
  buffer_load_dword v236, v246, s[16:19], s49 offen
  s_add_u32 s50, s49, 8192
  buffer_load_dword v237, v246, s[16:19], s50 offen
  s_add_u32 s50, s49, 13824
  buffer_load_dword v238, v246, s[16:19], s50 offen
  buffer_store_dwordx2 v[168:169], v176, s[32:35], s80 offen offset:0 sc1
  buffer_store_dwordx2 v[170:171], v176, s[32:35], s80 offen offset:512 sc1
  buffer_store_dwordx2 v[172:173], v176, s[32:35], s81 offen offset:0 sc1
  buffer_store_dwordx2 v[174:175], v176, s[32:35], s81 offen offset:512 sc1
  s_add_u32 m0, s69, 151552
  s_add_u32 s70, s68, 0
  buffer_load_dwordx4 v243, s[16:19], s70 offen  lds
  s_add_u32 m0, s69, 155648
  s_add_u32 s70, s68, 16384
  buffer_load_dwordx4 v243, s[16:19], s70 offen  lds
  s_add_u32 m0, s69, 159744
  s_add_u32 s70, s68, 32768
  buffer_load_dwordx4 v243, s[16:19], s70 offen  lds
  s_add_u32 m0, s69, 53248
  s_add_u32 s70, s68, 49152
  buffer_load_dwordx4 v243, s[16:19], s70 offen  lds
  s_add_u32 m0, s69, 57344
  s_add_u32 s70, s68, 65536
  buffer_load_dwordx4 v243, s[16:19], s70 offen  lds
  s_add_u32 m0, s69, 61440
  s_add_u32 s70, s68, 81920
  buffer_load_dwordx4 v243, s[16:19], s70 offen  lds
  s_add_u32 m0, s69, 65536
  s_add_u32 s70, s68, 98304
  buffer_load_dwordx4 v243, s[16:19], s70 offen  lds
  s_add_u32 m0, s69, 69632
  s_add_u32 s70, s68, 114688
  buffer_load_dwordx4 v243, s[16:19], s70 offen  lds
  s_add_u32 m0, s69, 73728
  s_add_u32 s70, s68, 131072
  buffer_load_dwordx4 v243, s[16:19], s70 offen  lds
  s_add_u32 m0, s69, 77824
  s_add_u32 s70, s68, 147456
  buffer_load_dwordx4 v243, s[16:19], s70 offen  lds
  s_add_u32 m0, s69, 81920
  s_add_u32 s70, s68, 163840
  buffer_load_dwordx4 v243, s[16:19], s70 offen  lds
  s_add_u32 m0, s69, 86016
  s_add_u32 s70, s68, 180224
  buffer_load_dwordx4 v243, s[16:19], s70 offen  lds
  s_add_u32 m0, s69, 90112
  s_add_u32 s70, s68, 196608
  buffer_load_dwordx4 v243, s[16:19], s70 offen  lds
  s_add_u32 m0, s69, 94208
  s_add_u32 s70, s68, 212992
  buffer_load_dwordx4 v243, s[16:19], s70 offen  lds
  s_add_u32 m0, s69, 98304
  s_add_u32 s70, s68, 229376
  buffer_load_dwordx4 v243, s[16:19], s70 offen  lds
  s_add_u32 m0, s69, 102400
  s_add_u32 s70, s68, 245760
  buffer_load_dwordx4 v243, s[16:19], s70 offen  lds
  s_add_u32 m0, s69, 106496
  s_add_u32 s70, s68, 262144
  buffer_load_dwordx4 v243, s[16:19], s70 offen  lds
  s_add_u32 m0, s69, 110592
  s_add_u32 s70, s68, 278528
  buffer_load_dwordx4 v243, s[16:19], s70 offen  lds
  s_add_u32 m0, s69, 114688
  s_add_u32 s70, s68, 294912
  buffer_load_dwordx4 v243, s[16:19], s70 offen  lds
  s_add_u32 m0, s69, 118784
  s_add_u32 s70, s68, 311296
  buffer_load_dwordx4 v243, s[16:19], s70 offen  lds
  s_add_u32 m0, s69, 122880
  s_add_u32 s70, s68, 327680
  buffer_load_dwordx4 v243, s[16:19], s70 offen  lds
  s_add_u32 m0, s69, 126976
  s_add_u32 s70, s68, 344064
  buffer_load_dwordx4 v243, s[16:19], s70 offen  lds
  s_add_u32 m0, s69, 131072
  s_add_u32 s70, s68, 360448
  buffer_load_dwordx4 v243, s[16:19], s70 offen  lds
  s_add_u32 m0, s69, 135168
  s_add_u32 s70, s68, 376832
  buffer_load_dwordx4 v243, s[16:19], s70 offen  lds
  s_add_u32 m0, s69, 139264
  s_add_u32 s70, s68, 393216
  buffer_load_dwordx4 v243, s[16:19], s70 offen  lds
  s_add_u32 m0, s69, 143360
  s_add_u32 s70, s68, 409600
  buffer_load_dwordx4 v243, s[16:19], s70 offen  lds
  s_add_u32 m0, s69, 147456
  s_add_u32 s70, s68, 425984
  buffer_load_dwordx4 v243, s[16:19], s70 offen  lds
  s_waitcnt vmcnt(0)
.k3done_27:
  s_waitcnt vmcnt(0) lgkmcnt(0)
  s_barrier
  s_cmp_lg_u32 s3, 0
  s_cbranch_scc1 .fs_29
  v_mov_b32 v250, 0
  v_mov_b32 v251, s64
  s_mov_b64 exec, 1
  buffer_store_dword v251, v250, s[32:35], s61 offen sc1
  s_mov_b64 exec, -1
.fs_29:
  s_and_b32 s36, s2, 7
  s_lshl_b32 s36, s36, 2
  s_bfe_u32 s38, s2, 0x20003
  s_add_u32 s36, s36, s38
  s_lshr_b32 s37, s2, 5
  s_lshr_b32 s38, s3, 1
  s_and_b32 s39, s3, 1
  s_mov_b32 s62, 14811136
  s_lshr_b32 s51, s36, 1
  s_lshl_b32 s51, s51, 4
  v_cmp_eq_u32 vcc, 15, v2
  s_nop 1
  v_cndmask_b32 v250, v2, 0, vcc
  v_add_u32 v250, s51, v250
  v_and_b32 v251, 7, v1
  v_lshlrev_b32 v251, 5, v251
  s_and_b32 s51, s36, 7
  s_lshr_b32 s52, s36, 3
  s_lshl_b32 s52, s52, 3
  s_add_u32 s51, s51, s52
  v_add_u32 v251, s51, v251
  v_bfe_u32 v252, v251, 1, 2
  v_lshlrev_b32 v252, 2, v252
  v_bfe_u32 v253, v251, 3, 2
  v_add_u32 v252, v252, v253
  v_and_b32 v253, 1, v251
  v_lshlrev_b32 v253, 3, v253
  v_lshrrev_b32 v251, 5, v251
  v_add_u32 v251, v251, v253
  v_lshl_add_u32 v251, v252, 4, v251
  v_cmp_gt_u32 vcc, 16, v1
  s_nop 1
  v_cndmask_b32 v250, v251, v250, vcc
  v_lshlrev_b32 v250, 7, v250
  s_lshl_b32 s44, s36, 1
  s_add_u32 s44, s44, s39
  s_mul_i32 s44, s44, 88064
  s_mul_i32 s45, s38, 44032
  s_add_u32 s44, s44, s45
  s_add_u32 s44, s44, 8388608
  v_lshlrev_b32 v4, 4, v1
  v_lshrrev_b32 v8, 3, v0
  v_and_b32 v9, 7, v0
  s_lshl_b32 s46, s36, 16
  s_lshl_b32 s47, s37, 7
  s_add_u32 s46, s46, s47
  s_add_u32 s46, s46, 5242880
  s_add_u32 s48, s46, 32768
  v_lshlrev_b32 v10, 10, v8
  v_lshl_add_u32 v10, v9, 4, v10
  v_lshlrev_b32 v11, 5, v9
  s_lshl_b32 s47, s37, 8
  s_add_u32 s47, s47, 2369536
  s_sub_u32 s49, 64, s36
  s_cmp_eq_u32 s36, 0
  s_cselect_b32 s49, 32, s49
  v_and_b32 v12, 1, v8
  v_cmp_ne_u32 vcc, 0, v12
  v_mov_b32 v12, s36
  v_mov_b32 v13, s49
  v_cndmask_b32 v12, v12, v13, vcc
  v_lshrrev_b32 v13, 1, v8
  v_lshl_add_u32 v12, v13, 6, v12
  v_lshlrev_b32 v12, 10, v12
  v_lshl_add_u32 v12, v9, 4, v12
  s_lshl_b32 s49, s37, 7
  s_add_u32 s50, s49, 0x100000
  v_bfe_u32 v6, v1, 2, 2
  v_bfe_u32 v7, v1, 5, 1
  v_lshl_add_u32 v7, v7, 2, v6
  v_lshlrev_b32 v7, 7, v7
  v_bfe_u32 v13, v1, 4, 1
  v_lshl_add_u32 v7, v13, 5, v7
  v_and_b32 v13, 3, v1
  v_lshl_add_u32 v7, v13, 3, v7
  s_lshl_b32 s41, s38, 11
  v_add_u32 v7, s41, v7
  v_bfe_u32 v13, v1, 3, 1
  v_lshlrev_b32 v13, 6, v13
  v_xor_b32 v6, v7, v13
  v_xor_b32 v7, 64, v6
  v_add_u32 v14, 0x10000, v6
  v_add_u32 v15, 0x10000, v7
  v_add_u32 v16, 0x20000, v6
  v_add_u32 v17, 0x20000, v7
  s_cmp_eq_u32 s3, 0
  s_cbranch_scc1 .p0_32
  s_add_u32 m0, s69, 0
  s_add_u32 s70, s68, 442368
  buffer_load_dwordx4 v243, s[16:19], s70 offen  lds
  s_add_u32 m0, s69, 4096
  s_add_u32 s70, s68, 458752
  buffer_load_dwordx4 v243, s[16:19], s70 offen  lds
  s_add_u32 m0, s69, 8192
  s_add_u32 s70, s68, 475136
  buffer_load_dwordx4 v243, s[16:19], s70 offen  lds
  s_add_u32 m0, s69, 12288
  s_add_u32 s70, s68, 491520
  buffer_load_dwordx4 v243, s[16:19], s70 offen  lds
  s_add_u32 m0, s69, 16384
  s_add_u32 s70, s68, 507904
  buffer_load_dwordx4 v243, s[16:19], s70 offen  lds
  s_add_u32 m0, s69, 20480
  s_add_u32 s70, s68, 524288
  buffer_load_dwordx4 v243, s[16:19], s70 offen  lds
  s_add_u32 m0, s69, 24576
  s_add_u32 s70, s68, 540672
  buffer_load_dwordx4 v243, s[16:19], s70 offen  lds
  s_add_u32 m0, s69, 28672
  s_add_u32 s70, s68, 557056
  buffer_load_dwordx4 v243, s[16:19], s70 offen  lds
  s_add_u32 m0, s69, 32768
  s_add_u32 s70, s68, 573440
  buffer_load_dwordx4 v243, s[16:19], s70 offen  lds
  s_add_u32 m0, s69, 36864
  s_add_u32 s70, s68, 589824
  buffer_load_dwordx4 v243, s[16:19], s70 offen  lds
  s_add_u32 m0, s69, 40960
  s_add_u32 s70, s68, 606208
  buffer_load_dwordx4 v243, s[16:19], s70 offen  lds
  s_add_u32 m0, s69, 45056
  s_add_u32 s70, s68, 622592
  buffer_load_dwordx4 v243, s[16:19], s70 offen  lds
  s_add_u32 m0, s69, 49152
  s_add_u32 s70, s68, 638976
  buffer_load_dwordx4 v243, s[16:19], s70 offen  lds
  s_lshl_b32 s74, s37, 7
  s_cmp_lg_u32 s3, 1
  s_cbranch_scc1 .wr_34
  s_mov_b32 m0, 0
  s_add_u32 s70, s74, 442368
  buffer_load_dwordx4 v243, s[16:19], s70 offen lds
  s_mov_b32 m0, 12288
  s_add_u32 s70, s74, 491520
  buffer_load_dwordx4 v243, s[16:19], s70 offen lds
  s_mov_b32 m0, 24576
  s_add_u32 s70, s74, 540672
  buffer_load_dwordx4 v243, s[16:19], s70 offen lds
  s_mov_b32 m0, 36864
  s_add_u32 s70, s74, 589824
  buffer_load_dwordx4 v243, s[16:19], s70 offen lds
  s_mov_b32 m0, 49152
  s_add_u32 s70, s74, 638976
  buffer_load_dwordx4 v243, s[16:19], s70 offen lds
.wr_34:
  s_cmp_lg_u32 s3, 2
  s_cbranch_scc1 .wr_35
  s_mov_b32 m0, 4096
  s_add_u32 s70, s74, 458752
  buffer_load_dwordx4 v243, s[16:19], s70 offen lds
  s_mov_b32 m0, 16384
  s_add_u32 s70, s74, 507904
  buffer_load_dwordx4 v243, s[16:19], s70 offen lds
  s_mov_b32 m0, 28672
  s_add_u32 s70, s74, 557056
  buffer_load_dwordx4 v243, s[16:19], s70 offen lds
  s_mov_b32 m0, 40960
  s_add_u32 s70, s74, 606208
  buffer_load_dwordx4 v243, s[16:19], s70 offen lds
.wr_35:
  s_cmp_lg_u32 s3, 3
  s_cbranch_scc1 .wr_36
  s_mov_b32 m0, 8192
  s_add_u32 s70, s74, 475136
  buffer_load_dwordx4 v243, s[16:19], s70 offen lds
  s_mov_b32 m0, 20480
  s_add_u32 s70, s74, 524288
  buffer_load_dwordx4 v243, s[16:19], s70 offen lds
  s_mov_b32 m0, 32768
  s_add_u32 s70, s74, 573440
  buffer_load_dwordx4 v243, s[16:19], s70 offen lds
  s_mov_b32 m0, 45056
  s_add_u32 s70, s74, 622592
  buffer_load_dwordx4 v243, s[16:19], s70 offen lds
.wr_36:
  s_branch .pj_33
.p0_32:
  s_mov_b32 s65, 0
  s_mov_b64 exec, 0xffffff
.pl_31:
  buffer_load_dword v252, v250, s[32:35], s62 offen sc1
  s_add_u32 s65, s65, 1
  s_waitcnt vmcnt(0)
  v_cmp_ne_u32 vcc, s64, v252
  s_cmp_ge_u32 s65, 400000
  s_cbranch_scc1 .pk_30
  s_and_b64 exec, exec, vcc
  s_cbranch_execz .pk_30
  s_branch .pl_31
.pk_30:
  s_mov_b64 exec, -1
.pj_33:
  s_barrier
  buffer_load_dwordx4 a[0:3], v4, s[32:35], s44 offen offset:0 sc1
  buffer_load_dwordx4 a[4:7], v4, s[32:35], s44 offen offset:1024 sc1
  buffer_load_dwordx4 a[8:11], v4, s[32:35], s44 offen offset:2048 sc1
  buffer_load_dwordx4 a[12:15], v4, s[32:35], s44 offen offset:3072 sc1
  s_add_u32 s44, s44, 4096
  buffer_load_dwordx4 a[16:19], v4, s[32:35], s44 offen offset:0 sc1
  buffer_load_dwordx4 a[20:23], v4, s[32:35], s44 offen offset:1024 sc1
  buffer_load_dwordx4 a[24:27], v4, s[32:35], s44 offen offset:2048 sc1
  buffer_load_dwordx4 a[28:31], v4, s[32:35], s44 offen offset:3072 sc1
  s_add_u32 s44, s44, 4096
  buffer_load_dwordx4 a[32:35], v4, s[32:35], s44 offen offset:0 sc1
  buffer_load_dwordx4 a[36:39], v4, s[32:35], s44 offen offset:1024 sc1
  buffer_load_dwordx4 a[40:43], v4, s[32:35], s44 offen offset:2048 sc1
  buffer_load_dwordx4 a[44:47], v4, s[32:35], s44 offen offset:3072 sc1
  ds_read_b64_tr_b16 v[64:65], v16 offset:20480
  ds_read_b64_tr_b16 v[66:67], v16 offset:21504
  ds_read_b64_tr_b16 v[68:69], v17 offset:20480
  ds_read_b64_tr_b16 v[70:71], v17 offset:21504
  ds_read_b64_tr_b16 v[72:73], v16 offset:24576
  ds_read_b64_tr_b16 v[74:75], v16 offset:25600
  ds_read_b64_tr_b16 v[76:77], v17 offset:24576
  ds_read_b64_tr_b16 v[78:79], v17 offset:25600
  ds_read_b64_tr_b16 v[80:81], v16 offset:28672
  ds_read_b64_tr_b16 v[82:83], v16 offset:29696
  ds_read_b64_tr_b16 v[84:85], v17 offset:28672
  ds_read_b64_tr_b16 v[86:87], v17 offset:29696
  s_waitcnt lgkmcnt(8)
  s_waitcnt vmcnt(11)
  v_mfma_f32_32x32x16_bf16 v[32:47], v[64:67], a[0:3], 0
  s_add_u32 s44, s44, 4096
  buffer_load_dwordx4 a[48:51], v4, s[32:35], s44 offen offset:0 sc1
  ds_read_b64_tr_b16 v[88:89], v6 offset:53248
  ds_read_b64_tr_b16 v[90:91], v6 offset:54272
  v_mfma_f32_32x32x16_bf16 v[48:63], v[68:71], a[0:3], 0
  buffer_load_dwordx4 a[52:55], v4, s[32:35], s44 offen offset:1024 sc1
  ds_read_b64_tr_b16 v[92:93], v7 offset:53248
  ds_read_b64_tr_b16 v[94:95], v7 offset:54272
  s_waitcnt lgkmcnt(8)
  s_waitcnt vmcnt(12)
  v_mfma_f32_32x32x16_bf16 v[32:47], v[72:75], a[4:7], v[32:47]
  buffer_load_dwordx4 a[56:59], v4, s[32:35], s44 offen offset:2048 sc1
  ds_read_b64_tr_b16 v[64:65], v6 offset:57344
  ds_read_b64_tr_b16 v[66:67], v6 offset:58368
  v_mfma_f32_32x32x16_bf16 v[48:63], v[76:79], a[4:7], v[48:63]
  buffer_load_dwordx4 a[60:63], v4, s[32:35], s44 offen offset:3072 sc1
  ds_read_b64_tr_b16 v[68:69], v7 offset:57344
  ds_read_b64_tr_b16 v[70:71], v7 offset:58368
  s_waitcnt lgkmcnt(8)
  s_waitcnt vmcnt(13)
  v_mfma_f32_32x32x16_bf16 v[32:47], v[80:83], a[8:11], v[32:47]
  s_add_u32 s44, s44, 4096
  buffer_load_dwordx4 a[64:67], v4, s[32:35], s44 offen offset:0 sc1
  ds_read_b64_tr_b16 v[72:73], v6 offset:61440
  ds_read_b64_tr_b16 v[74:75], v6 offset:62464
  v_mfma_f32_32x32x16_bf16 v[48:63], v[84:87], a[8:11], v[48:63]
  buffer_load_dwordx4 a[68:71], v4, s[32:35], s44 offen offset:1024 sc1
  ds_read_b64_tr_b16 v[76:77], v7 offset:61440
  ds_read_b64_tr_b16 v[78:79], v7 offset:62464
  s_waitcnt lgkmcnt(8)
  s_waitcnt vmcnt(14)
  v_mfma_f32_32x32x16_bf16 v[32:47], v[88:91], a[12:15], v[32:47]
  buffer_load_dwordx4 a[72:75], v4, s[32:35], s44 offen offset:2048 sc1
  ds_read_b64_tr_b16 v[80:81], v14 offset:0
  ds_read_b64_tr_b16 v[82:83], v14 offset:1024
  v_mfma_f32_32x32x16_bf16 v[48:63], v[92:95], a[12:15], v[48:63]
  buffer_load_dwordx4 a[76:79], v4, s[32:35], s44 offen offset:3072 sc1
  ds_read_b64_tr_b16 v[84:85], v15 offset:0
  ds_read_b64_tr_b16 v[86:87], v15 offset:1024
  s_waitcnt lgkmcnt(8)
  s_waitcnt vmcnt(15)
  v_mfma_f32_32x32x16_bf16 v[32:47], v[64:67], a[16:19], v[32:47]
  s_add_u32 s44, s44, 4096
  buffer_load_dwordx4 a[80:83], v4, s[32:35], s44 offen offset:0 sc1
  ds_read_b64_tr_b16 v[88:89], v14 offset:4096
  ds_read_b64_tr_b16 v[90:91], v14 offset:5120
  v_mfma_f32_32x32x16_bf16 v[48:63], v[68:71], a[16:19], v[48:63]
  buffer_load_dwordx4 a[84:87], v4, s[32:35], s44 offen offset:1024 sc1
  ds_read_b64_tr_b16 v[92:93], v15 offset:4096
  ds_read_b64_tr_b16 v[94:95], v15 offset:5120
  s_waitcnt lgkmcnt(8)
  s_waitcnt vmcnt(16)
  v_mfma_f32_32x32x16_bf16 v[32:47], v[72:75], a[20:23], v[32:47]
  buffer_load_dwordx4 a[88:91], v4, s[32:35], s44 offen offset:2048 sc1
  ds_read_b64_tr_b16 v[64:65], v14 offset:8192
  ds_read_b64_tr_b16 v[66:67], v14 offset:9216
  v_mfma_f32_32x32x16_bf16 v[48:63], v[76:79], a[20:23], v[48:63]
  buffer_load_dwordx4 a[92:95], v4, s[32:35], s44 offen offset:3072 sc1
  ds_read_b64_tr_b16 v[68:69], v15 offset:8192
  ds_read_b64_tr_b16 v[70:71], v15 offset:9216
  s_waitcnt lgkmcnt(8)
  s_waitcnt vmcnt(17)
  v_mfma_f32_32x32x16_bf16 v[32:47], v[80:83], a[24:27], v[32:47]
  s_add_u32 s44, s44, 4096
  buffer_load_dwordx4 a[96:99], v4, s[32:35], s44 offen offset:0 sc1
  ds_read_b64_tr_b16 v[72:73], v14 offset:12288
  ds_read_b64_tr_b16 v[74:75], v14 offset:13312
  v_mfma_f32_32x32x16_bf16 v[48:63], v[84:87], a[24:27], v[48:63]
  buffer_load_dwordx4 a[100:103], v4, s[32:35], s44 offen offset:1024 sc1
  ds_read_b64_tr_b16 v[76:77], v15 offset:12288
  ds_read_b64_tr_b16 v[78:79], v15 offset:13312
  s_waitcnt lgkmcnt(8)
  s_waitcnt vmcnt(18)
  v_mfma_f32_32x32x16_bf16 v[32:47], v[88:91], a[28:31], v[32:47]
  buffer_load_dwordx4 a[104:107], v4, s[32:35], s44 offen offset:2048 sc1
  ds_read_b64_tr_b16 v[80:81], v14 offset:16384
  ds_read_b64_tr_b16 v[82:83], v14 offset:17408
  v_mfma_f32_32x32x16_bf16 v[48:63], v[92:95], a[28:31], v[48:63]
  buffer_load_dwordx4 a[108:111], v4, s[32:35], s44 offen offset:3072 sc1
  ds_read_b64_tr_b16 v[84:85], v15 offset:16384
  ds_read_b64_tr_b16 v[86:87], v15 offset:17408
  s_waitcnt lgkmcnt(8)
  s_waitcnt vmcnt(19)
  v_mfma_f32_32x32x16_bf16 v[32:47], v[64:67], a[32:35], v[32:47]
  s_add_u32 s44, s44, 4096
  buffer_load_dwordx4 a[112:115], v4, s[32:35], s44 offen offset:0 sc1
  ds_read_b64_tr_b16 v[88:89], v14 offset:20480
  ds_read_b64_tr_b16 v[90:91], v14 offset:21504
  v_mfma_f32_32x32x16_bf16 v[48:63], v[68:71], a[32:35], v[48:63]
  buffer_load_dwordx4 a[116:119], v4, s[32:35], s44 offen offset:1024 sc1
  ds_read_b64_tr_b16 v[92:93], v15 offset:20480
  ds_read_b64_tr_b16 v[94:95], v15 offset:21504
  s_waitcnt lgkmcnt(8)
  s_waitcnt vmcnt(20)
  v_mfma_f32_32x32x16_bf16 v[32:47], v[72:75], a[36:39], v[32:47]
  buffer_load_dwordx4 a[120:123], v4, s[32:35], s44 offen offset:2048 sc1
  ds_read_b64_tr_b16 v[64:65], v14 offset:24576
  ds_read_b64_tr_b16 v[66:67], v14 offset:25600
  v_mfma_f32_32x32x16_bf16 v[48:63], v[76:79], a[36:39], v[48:63]
  buffer_load_dwordx4 a[124:127], v4, s[32:35], s44 offen offset:3072 sc1
  ds_read_b64_tr_b16 v[68:69], v15 offset:24576
  ds_read_b64_tr_b16 v[70:71], v15 offset:25600
  s_waitcnt lgkmcnt(8)
  s_waitcnt vmcnt(21)
  v_mfma_f32_32x32x16_bf16 v[32:47], v[80:83], a[40:43], v[32:47]
  s_add_u32 s44, s44, 4096
  buffer_load_dwordx4 a[128:131], v4, s[32:35], s44 offen offset:0 sc1
  ds_read_b64_tr_b16 v[72:73], v14 offset:28672
  ds_read_b64_tr_b16 v[74:75], v14 offset:29696
  v_mfma_f32_32x32x16_bf16 v[48:63], v[84:87], a[40:43], v[48:63]
  buffer_load_dwordx4 a[132:135], v4, s[32:35], s44 offen offset:1024 sc1
  ds_read_b64_tr_b16 v[76:77], v15 offset:28672
  ds_read_b64_tr_b16 v[78:79], v15 offset:29696
  s_waitcnt lgkmcnt(8)
  s_waitcnt vmcnt(22)
  v_mfma_f32_32x32x16_bf16 v[32:47], v[88:91], a[44:47], v[32:47]
  buffer_load_dwordx4 a[136:139], v4, s[32:35], s44 offen offset:2048 sc1
  ds_read_b64_tr_b16 v[80:81], v14 offset:32768
  ds_read_b64_tr_b16 v[82:83], v14 offset:33792
  v_mfma_f32_32x32x16_bf16 v[48:63], v[92:95], a[44:47], v[48:63]
  buffer_load_dwordx4 a[140:143], v4, s[32:35], s44 offen offset:3072 sc1
  ds_read_b64_tr_b16 v[84:85], v15 offset:32768
  ds_read_b64_tr_b16 v[86:87], v15 offset:33792
  s_waitcnt lgkmcnt(8)
  s_waitcnt vmcnt(23)
  v_mfma_f32_32x32x16_bf16 v[32:47], v[64:67], a[48:51], v[32:47]
  s_add_u32 s44, s44, 4096
  buffer_load_dwordx4 a[144:147], v4, s[32:35], s44 offen offset:0 sc1
  ds_read_b64_tr_b16 v[88:89], v14 offset:36864
  ds_read_b64_tr_b16 v[90:91], v14 offset:37888
  v_mfma_f32_32x32x16_bf16 v[48:63], v[68:71], a[48:51], v[48:63]
  buffer_load_dwordx4 a[148:151], v4, s[32:35], s44 offen offset:1024 sc1
  ds_read_b64_tr_b16 v[92:93], v15 offset:36864
  ds_read_b64_tr_b16 v[94:95], v15 offset:37888
  s_waitcnt lgkmcnt(8)
  s_waitcnt vmcnt(24)
  v_mfma_f32_32x32x16_bf16 v[32:47], v[72:75], a[52:55], v[32:47]
  buffer_load_dwordx4 a[152:155], v4, s[32:35], s44 offen offset:2048 sc1
  ds_read_b64_tr_b16 v[64:65], v14 offset:40960
  ds_read_b64_tr_b16 v[66:67], v14 offset:41984
  v_mfma_f32_32x32x16_bf16 v[48:63], v[76:79], a[52:55], v[48:63]
  buffer_load_dwordx4 a[156:159], v4, s[32:35], s44 offen offset:3072 sc1
  ds_read_b64_tr_b16 v[68:69], v15 offset:40960
  ds_read_b64_tr_b16 v[70:71], v15 offset:41984
  s_waitcnt lgkmcnt(8)
  s_waitcnt vmcnt(25)
  v_mfma_f32_32x32x16_bf16 v[32:47], v[80:83], a[56:59], v[32:47]
  s_add_u32 s44, s44, 4096
  buffer_load_dwordx4 a[160:163], v4, s[32:35], s44 offen offset:0 sc1
  ds_read_b64_tr_b16 v[72:73], v14 offset:45056
  ds_read_b64_tr_b16 v[74:75], v14 offset:46080
  v_mfma_f32_32x32x16_bf16 v[48:63], v[84:87], a[56:59], v[48:63]
  buffer_load_dwordx4 a[164:167], v4, s[32:35], s44 offen offset:1024 sc1
  ds_read_b64_tr_b16 v[76:77], v15 offset:45056
  ds_read_b64_tr_b16 v[78:79], v15 offset:46080
  s_waitcnt lgkmcnt(8)
  s_waitcnt vmcnt(26)
  v_mfma_f32_32x32x16_bf16 v[32:47], v[88:91], a[60:63], v[32:47]
  buffer_load_dwordx4 a[168:171], v4, s[32:35], s44 offen offset:2048 sc1
  ds_read_b64_tr_b16 v[80:81], v14 offset:49152
  ds_read_b64_tr_b16 v[82:83], v14 offset:50176
  v_mfma_f32_32x32x16_bf16 v[48:63], v[92:95], a[60:63], v[48:63]
  ds_read_b64_tr_b16 v[84:85], v15 offset:49152
  ds_read_b64_tr_b16 v[86:87], v15 offset:50176
  s_waitcnt lgkmcnt(8)
  s_waitcnt vmcnt(26)
  v_mfma_f32_32x32x16_bf16 v[32:47], v[64:67], a[64:67], v[32:47]
  ds_read_b64_tr_b16 v[88:89], v14 offset:53248
  ds_read_b64_tr_b16 v[90:91], v14 offset:54272
  v_mfma_f32_32x32x16_bf16 v[48:63], v[68:71], a[64:67], v[48:63]
  ds_read_b64_tr_b16 v[92:93], v15 offset:53248
  ds_read_b64_tr_b16 v[94:95], v15 offset:54272
  s_waitcnt lgkmcnt(8)
  s_waitcnt vmcnt(25)
  v_mfma_f32_32x32x16_bf16 v[32:47], v[72:75], a[68:71], v[32:47]
  ds_read_b64_tr_b16 v[64:65], v14 offset:57344
  ds_read_b64_tr_b16 v[66:67], v14 offset:58368
  v_mfma_f32_32x32x16_bf16 v[48:63], v[76:79], a[68:71], v[48:63]
  ds_read_b64_tr_b16 v[68:69], v15 offset:57344
  ds_read_b64_tr_b16 v[70:71], v15 offset:58368
  s_waitcnt lgkmcnt(8)
  s_waitcnt vmcnt(24)
  v_mfma_f32_32x32x16_bf16 v[32:47], v[80:83], a[72:75], v[32:47]
  ds_read_b64_tr_b16 v[72:73], v14 offset:61440
  ds_read_b64_tr_b16 v[74:75], v14 offset:62464
  v_mfma_f32_32x32x16_bf16 v[48:63], v[84:87], a[72:75], v[48:63]
  ds_read_b64_tr_b16 v[76:77], v15 offset:61440
  ds_read_b64_tr_b16 v[78:79], v15 offset:62464
  s_waitcnt lgkmcnt(8)
  s_waitcnt vmcnt(23)
  v_mfma_f32_32x32x16_bf16 v[32:47], v[88:91], a[76:79], v[32:47]
  ds_read_b64_tr_b16 v[80:81], v16 offset:0
  ds_read_b64_tr_b16 v[82:83], v16 offset:1024
  v_mfma_f32_32x32x16_bf16 v[48:63], v[92:95], a[76:79], v[48:63]
  ds_read_b64_tr_b16 v[84:85], v17 offset:0
  ds_read_b64_tr_b16 v[86:87], v17 offset:1024
  s_waitcnt lgkmcnt(8)
  s_waitcnt vmcnt(22)
  v_mfma_f32_32x32x16_bf16 v[32:47], v[64:67], a[80:83], v[32:47]
  ds_read_b64_tr_b16 v[88:89], v16 offset:4096
  ds_read_b64_tr_b16 v[90:91], v16 offset:5120
  v_mfma_f32_32x32x16_bf16 v[48:63], v[68:71], a[80:83], v[48:63]
  ds_read_b64_tr_b16 v[92:93], v17 offset:4096
  ds_read_b64_tr_b16 v[94:95], v17 offset:5120
  s_waitcnt lgkmcnt(8)
  s_waitcnt vmcnt(21)
  v_mfma_f32_32x32x16_bf16 v[32:47], v[72:75], a[84:87], v[32:47]
  ds_read_b64_tr_b16 v[64:65], v16 offset:8192
  ds_read_b64_tr_b16 v[66:67], v16 offset:9216
  v_mfma_f32_32x32x16_bf16 v[48:63], v[76:79], a[84:87], v[48:63]
  ds_read_b64_tr_b16 v[68:69], v17 offset:8192
  ds_read_b64_tr_b16 v[70:71], v17 offset:9216
  s_waitcnt lgkmcnt(8)
  s_waitcnt vmcnt(20)
  v_mfma_f32_32x32x16_bf16 v[32:47], v[80:83], a[88:91], v[32:47]
  ds_read_b64_tr_b16 v[72:73], v16 offset:12288
  ds_read_b64_tr_b16 v[74:75], v16 offset:13312
  v_mfma_f32_32x32x16_bf16 v[48:63], v[84:87], a[88:91], v[48:63]
  ds_read_b64_tr_b16 v[76:77], v17 offset:12288
  ds_read_b64_tr_b16 v[78:79], v17 offset:13312
  s_waitcnt lgkmcnt(8)
  s_waitcnt vmcnt(19)
  v_mfma_f32_32x32x16_bf16 v[32:47], v[88:91], a[92:95], v[32:47]
  ds_read_b64_tr_b16 v[80:81], v16 offset:16384
  ds_read_b64_tr_b16 v[82:83], v16 offset:17408
  v_mfma_f32_32x32x16_bf16 v[48:63], v[92:95], a[92:95], v[48:63]
  s_barrier
  s_add_u32 m0, s69, 151552
  s_add_u32 s70, s68, 655360
  buffer_load_dwordx4 v243, s[16:19], s70 offen  lds
  s_add_u32 m0, s69, 155648
  s_add_u32 s70, s68, 671744
  buffer_load_dwordx4 v243, s[16:19], s70 offen  lds
  s_add_u32 m0, s69, 159744
  s_add_u32 s70, s68, 688128
  buffer_load_dwordx4 v243, s[16:19], s70 offen  lds
  buffer_load_dwordx4 v[96:99], v10, s[32:35], s46 offen sc1
  buffer_load_dwordx4 v[100:103], v10, s[32:35], s48 offen sc1
  buffer_load_dwordx4 v[104:107], v11, s[32:35], s47 offen sc1
  buffer_load_dwordx4 v[108:111], v11, s[32:35], s47 offen offset:16 sc1
  ds_read_b64_tr_b16 v[84:85], v17 offset:16384
  ds_read_b64_tr_b16 v[86:87], v17 offset:17408
  s_waitcnt lgkmcnt(8)
  s_waitcnt vmcnt(25)
  v_mfma_f32_32x32x16_bf16 v[32:47], v[64:67], a[96:99], v[32:47]
  ds_read_b64_tr_b16 v[88:89], v6 offset:0
  ds_read_b64_tr_b16 v[90:91], v6 offset:1024
  v_mfma_f32_32x32x16_bf16 v[48:63], v[68:71], a[96:99], v[48:63]
  ds_read_b64_tr_b16 v[92:93], v7 offset:0
  ds_read_b64_tr_b16 v[94:95], v7 offset:1024
  s_waitcnt lgkmcnt(8)
  s_waitcnt vmcnt(24)
  v_mfma_f32_32x32x16_bf16 v[32:47], v[72:75], a[100:103], v[32:47]
  ds_read_b64_tr_b16 v[64:65], v6 offset:4096
  ds_read_b64_tr_b16 v[66:67], v6 offset:5120
  v_mfma_f32_32x32x16_bf16 v[48:63], v[76:79], a[100:103], v[48:63]
  ds_read_b64_tr_b16 v[68:69], v7 offset:4096
  ds_read_b64_tr_b16 v[70:71], v7 offset:5120
  s_waitcnt lgkmcnt(8)
  s_waitcnt vmcnt(23)
  v_mfma_f32_32x32x16_bf16 v[32:47], v[80:83], a[104:107], v[32:47]
  ds_read_b64_tr_b16 v[72:73], v6 offset:8192
  ds_read_b64_tr_b16 v[74:75], v6 offset:9216
  v_mfma_f32_32x32x16_bf16 v[48:63], v[84:87], a[104:107], v[48:63]
  ds_read_b64_tr_b16 v[76:77], v7 offset:8192
  ds_read_b64_tr_b16 v[78:79], v7 offset:9216
  s_waitcnt lgkmcnt(8)
  s_waitcnt vmcnt(22)
  v_mfma_f32_32x32x16_bf16 v[32:47], v[88:91], a[108:111], v[32:47]
  ds_read_b64_tr_b16 v[80:81], v6 offset:12288
  ds_read_b64_tr_b16 v[82:83], v6 offset:13312
  v_mfma_f32_32x32x16_bf16 v[48:63], v[92:95], a[108:111], v[48:63]
  ds_read_b64_tr_b16 v[84:85], v7 offset:12288
  ds_read_b64_tr_b16 v[86:87], v7 offset:13312
  s_waitcnt lgkmcnt(8)
  s_waitcnt vmcnt(21)
  v_mfma_f32_32x32x16_bf16 v[32:47], v[64:67], a[112:115], v[32:47]
  ds_read_b64_tr_b16 v[88:89], v6 offset:16384
  ds_read_b64_tr_b16 v[90:91], v6 offset:17408
  v_mfma_f32_32x32x16_bf16 v[48:63], v[68:71], a[112:115], v[48:63]
  ds_read_b64_tr_b16 v[92:93], v7 offset:16384
  ds_read_b64_tr_b16 v[94:95], v7 offset:17408
  s_waitcnt lgkmcnt(8)
  s_waitcnt vmcnt(20)
  v_mfma_f32_32x32x16_bf16 v[32:47], v[72:75], a[116:119], v[32:47]
  ds_read_b64_tr_b16 v[64:65], v6 offset:20480
  ds_read_b64_tr_b16 v[66:67], v6 offset:21504
  v_mfma_f32_32x32x16_bf16 v[48:63], v[76:79], a[116:119], v[48:63]
  ds_read_b64_tr_b16 v[68:69], v7 offset:20480
  ds_read_b64_tr_b16 v[70:71], v7 offset:21504
  s_waitcnt lgkmcnt(8)
  s_waitcnt vmcnt(19)
  v_mfma_f32_32x32x16_bf16 v[32:47], v[80:83], a[120:123], v[32:47]
  ds_read_b64_tr_b16 v[72:73], v6 offset:24576
  ds_read_b64_tr_b16 v[74:75], v6 offset:25600
  v_mfma_f32_32x32x16_bf16 v[48:63], v[84:87], a[120:123], v[48:63]
  ds_read_b64_tr_b16 v[76:77], v7 offset:24576
  ds_read_b64_tr_b16 v[78:79], v7 offset:25600
  s_waitcnt lgkmcnt(8)
  s_waitcnt vmcnt(18)
  v_mfma_f32_32x32x16_bf16 v[32:47], v[88:91], a[124:127], v[32:47]
  ds_read_b64_tr_b16 v[80:81], v6 offset:28672
  ds_read_b64_tr_b16 v[82:83], v6 offset:29696
  v_mfma_f32_32x32x16_bf16 v[48:63], v[92:95], a[124:127], v[48:63]
  ds_read_b64_tr_b16 v[84:85], v7 offset:28672
  ds_read_b64_tr_b16 v[86:87], v7 offset:29696
  s_waitcnt lgkmcnt(8)
  s_waitcnt vmcnt(17)
  v_mfma_f32_32x32x16_bf16 v[32:47], v[64:67], a[128:131], v[32:47]
  ds_read_b64_tr_b16 v[88:89], v6 offset:32768
  ds_read_b64_tr_b16 v[90:91], v6 offset:33792
  v_mfma_f32_32x32x16_bf16 v[48:63], v[68:71], a[128:131], v[48:63]
  ds_read_b64_tr_b16 v[92:93], v7 offset:32768
  ds_read_b64_tr_b16 v[94:95], v7 offset:33792
  s_waitcnt lgkmcnt(8)
  s_waitcnt vmcnt(16)
  v_mfma_f32_32x32x16_bf16 v[32:47], v[72:75], a[132:135], v[32:47]
  ds_read_b64_tr_b16 v[64:65], v6 offset:36864
  ds_read_b64_tr_b16 v[66:67], v6 offset:37888
  v_mfma_f32_32x32x16_bf16 v[48:63], v[76:79], a[132:135], v[48:63]
  ds_read_b64_tr_b16 v[68:69], v7 offset:36864
  ds_read_b64_tr_b16 v[70:71], v7 offset:37888
  s_waitcnt lgkmcnt(8)
  s_waitcnt vmcnt(15)
  v_mfma_f32_32x32x16_bf16 v[32:47], v[80:83], a[136:139], v[32:47]
  ds_read_b64_tr_b16 v[72:73], v6 offset:40960
  ds_read_b64_tr_b16 v[74:75], v6 offset:41984
  v_mfma_f32_32x32x16_bf16 v[48:63], v[84:87], a[136:139], v[48:63]
  ds_read_b64_tr_b16 v[76:77], v7 offset:40960
  ds_read_b64_tr_b16 v[78:79], v7 offset:41984
  s_waitcnt lgkmcnt(8)
  s_waitcnt vmcnt(14)
  v_mfma_f32_32x32x16_bf16 v[32:47], v[88:91], a[140:143], v[32:47]
  ds_read_b64_tr_b16 v[80:81], v6 offset:45056
  ds_read_b64_tr_b16 v[82:83], v6 offset:46080
  v_mfma_f32_32x32x16_bf16 v[48:63], v[92:95], a[140:143], v[48:63]
  ds_read_b64_tr_b16 v[84:85], v7 offset:45056
  ds_read_b64_tr_b16 v[86:87], v7 offset:46080
  s_waitcnt lgkmcnt(8)
  s_waitcnt vmcnt(13)
  v_mfma_f32_32x32x16_bf16 v[32:47], v[64:67], a[144:147], v[32:47]
  ds_read_b64_tr_b16 v[88:89], v6 offset:49152
  ds_read_b64_tr_b16 v[90:91], v6 offset:50176
  v_mfma_f32_32x32x16_bf16 v[48:63], v[68:71], a[144:147], v[48:63]
  s_waitcnt vmcnt(4)
  s_barrier
  s_mul_i32 s51, s3, 8704
  v_and_b32 v18, 31, v1
  v_mul_u32_u24 v18, 272, v18
  v_bfe_u32 v19, v1, 5, 1
  v_lshl_add_u32 v18, v19, 4, v18
  v_add_u32 v18, s51, v18
  v_mul_u32_u24 v19, 272, v8
  v_lshl_add_u32 v19, v9, 5, v19
  ds_read_b64_tr_b16 v[92:93], v16 offset:20480
  ds_read_b64_tr_b16 v[94:95], v16 offset:21504
  s_waitcnt lgkmcnt(8)
  v_mfma_f32_32x32x16_bf16 v[32:47], v[72:75], a[148:151], v[32:47]
  ds_read_b64_tr_b16 v[64:65], v16 offset:24576
  ds_read_b64_tr_b16 v[66:67], v16 offset:25600
  v_mfma_f32_32x32x16_bf16 v[48:63], v[76:79], a[148:151], v[48:63]
  ds_read_b64_tr_b16 v[68:69], v16 offset:28672
  ds_read_b64_tr_b16 v[70:71], v16 offset:29696
  s_waitcnt lgkmcnt(8)
  v_mfma_f32_32x32x16_bf16 v[32:47], v[80:83], a[152:155], v[32:47]
  ds_read_b64_tr_b16 v[72:73], v7 offset:49152
  ds_read_b64_tr_b16 v[74:75], v7 offset:50176
  v_mfma_f32_32x32x16_bf16 v[48:63], v[84:87], a[152:155], v[48:63]
  ds_read_b64_tr_b16 v[76:77], v17 offset:20480
  ds_read_b64_tr_b16 v[78:79], v17 offset:21504
  s_waitcnt lgkmcnt(8)
  v_mfma_f32_32x32x16_bf16 v[32:47], v[88:91], a[156:159], v[32:47]
  ds_read_b64_tr_b16 v[80:81], v17 offset:24576
  ds_read_b64_tr_b16 v[82:83], v17 offset:25600
  v_mfma_f32_32x32x16_bf16 v[32:47], v[92:95], a[160:163], v[32:47]
  ds_read_b64_tr_b16 v[84:85], v17 offset:28672
  ds_read_b64_tr_b16 v[86:87], v17 offset:29696
  s_waitcnt lgkmcnt(8)
  v_mfma_f32_32x32x16_bf16 v[32:47], v[64:67], a[164:167], v[32:47]
  v_mfma_f32_32x32x16_bf16 v[32:47], v[68:71], a[168:171], v[32:47]
  s_waitcnt lgkmcnt(4)
  v_mfma_f32_32x32x16_bf16 v[48:63], v[72:75], a[156:159], v[48:63]
  v_mfma_f32_32x32x16_bf16 v[48:63], v[76:79], a[160:163], v[48:63]
  s_nop 8
  ds_write_b128 v18, v[32:35] offset:0
  ds_write_b128 v18, v[36:39] offset:32
  s_waitcnt lgkmcnt(2)
  v_mfma_f32_32x32x16_bf16 v[48:63], v[80:83], a[164:167], v[48:63]
  ds_write_b128 v18, v[40:43] offset:64
  v_mfma_f32_32x32x16_bf16 v[48:63], v[84:87], a[168:171], v[48:63]
  ds_write_b128 v18, v[44:47] offset:96
  s_waitcnt vmcnt(3)
  v_lshlrev_b32 v112, 16, v96
  v_and_b32 v113, 0xffff0000, v96
  v_lshlrev_b32 v114, 16, v97
  v_and_b32 v115, 0xffff0000, v97
  v_lshlrev_b32 v116, 16, v98
  v_and_b32 v117, 0xffff0000, v98
  v_lshlrev_b32 v118, 16, v99
  v_and_b32 v119, 0xffff0000, v99
  s_waitcnt vmcnt(2)
  v_lshlrev_b32 v120, 16, v100
  v_and_b32 v121, 0xffff0000, v100
  v_lshlrev_b32 v122, 16, v101
  v_and_b32 v123, 0xffff0000, v101
  v_lshlrev_b32 v124, 16, v102
  v_and_b32 v125, 0xffff0000, v102
  v_lshlrev_b32 v126, 16, v103
  v_and_b32 v127, 0xffff0000, v103
  ds_write_b128 v18, v[48:51] offset:128
  ds_write_b128 v18, v[52:55] offset:160
  ds_write_b128 v18, v[56:59] offset:192
  ds_write_b128 v18, v[60:63] offset:224
  s_waitcnt lgkmcnt(0)
  s_barrier
  ds_read_b128 v[128:131], v19 offset:0
  ds_read_b128 v[132:135], v19 offset:16
  ds_read_b128 v[136:139], v19 offset:17408
  ds_read_b128 v[140:143], v19 offset:17424
  ds_read_b128 v[144:147], v19 offset:8704
  ds_read_b128 v[148:151], v19 offset:8720
  ds_read_b128 v[152:155], v19 offset:26112
  ds_read_b128 v[156:159], v19 offset:26128
  s_waitcnt lgkmcnt(5)
  v_pk_add_f32 v[128:129], v[128:129], v[136:137]
  v_pk_add_f32 v[130:131], v[130:131], v[138:139]
  s_waitcnt lgkmcnt(4)
  v_pk_add_f32 v[132:133], v[132:133], v[140:141]
  v_pk_add_f32 v[134:135], v[134:135], v[142:143]
  s_waitcnt vmcnt(1)
  v_pk_fma_f32 v[128:129], v[128:129], v[104:105], v[112:113]
  v_pk_fma_f32 v[130:131], v[130:131], v[106:107], v[114:115]
  s_waitcnt vmcnt(0)
  v_pk_fma_f32 v[132:133], v[132:133], v[108:109], v[116:117]
  v_pk_fma_f32 v[134:135], v[134:135], v[110:111], v[118:119]
  v_cvt_pk_bf16_f32 v136, v128, v129
  v_cvt_pk_bf16_f32 v137, v130, v131
  v_cvt_pk_bf16_f32 v138, v132, v133
  v_cvt_pk_bf16_f32 v139, v134, v135
  buffer_store_dwordx4 v[136:139], v12, s[28:31], s49 offen sc1
  s_waitcnt lgkmcnt(1)
  v_pk_add_f32 v[144:145], v[144:145], v[152:153]
  v_pk_add_f32 v[146:147], v[146:147], v[154:155]
  s_waitcnt lgkmcnt(0)
  v_pk_add_f32 v[148:149], v[148:149], v[156:157]
  v_pk_add_f32 v[150:151], v[150:151], v[158:159]
  v_pk_fma_f32 v[144:145], v[144:145], v[104:105], v[120:121]
  v_pk_fma_f32 v[146:147], v[146:147], v[106:107], v[122:123]
  v_pk_fma_f32 v[148:149], v[148:149], v[108:109], v[124:125]
  v_pk_fma_f32 v[150:151], v[150:151], v[110:111], v[126:127]
  v_cvt_pk_bf16_f32 v152, v144, v145
  v_cvt_pk_bf16_f32 v153, v146, v147
  v_cvt_pk_bf16_f32 v154, v148, v149
  v_cvt_pk_bf16_f32 v155, v150, v151
  buffer_store_dwordx4 v[152:155], v12, s[28:31], s50 offen sc1
  s_or_b32 s63, s2, s3
  s_cmp_lg_u32 s63, 0
  s_cbranch_scc1 .ep_37
  v_mov_b32 v250, 0
  v_mov_b32 v251, s64
  s_mov_b32 s63, 14680064
  s_mov_b64 exec, 1
  buffer_store_dword v251, v250, s[32:35], s63 offen sc1
  s_mov_b64 exec, -1
.ep_37:
.done_1:
.Lend:
  s_endpgm

.section .rodata,"a"
.p2align 6
.amdhsa_kernel adaLN_cond__spectral_fnet__swiglu_ffn__prompt_kernel
  .amdhsa_next_free_vgpr 428
  .amdhsa_next_free_sgpr 102
  .amdhsa_accum_offset 256
  .amdhsa_group_segment_fixed_size 0
  .amdhsa_kernarg_size 112
  .amdhsa_user_sgpr_count 2
  .amdhsa_user_sgpr_kernarg_segment_ptr 1
  .amdhsa_system_sgpr_workgroup_id_x 1
  .amdhsa_float_denorm_mode_32 3
.end_amdhsa_kernel
```
